```python
import torch

def _softmax(x, axis=-1):
    return torch.softmax(x, dim=axis)
def _gelu(x):
    return torch.nn.functional.gelu(x, approximate="tanh")
def _silu(x):
    return torch.nn.functional.silu(x)
def _sigmoid(x):
    return torch.sigmoid(x)
def _layernorm(x, axis=-1, eps=1e-5):
    m = x.mean(dim=axis, keepdim=True)
    v = x.var(dim=axis, keepdim=True, unbiased=False)
    return (x - m) / torch.sqrt(v + eps)
def _scatter_add(tgt, idx, src, axis=0):
    return tgt.clone().index_add_(axis, idx, src)
def _segment_sum(src, seg, n):
    out = torch.zeros((n,) + src.shape[1:], dtype=src.dtype)
    return out.index_add_(0, seg, src)
def _pad(x, pw):
    flat = tuple(v for pair in reversed(pw) for v in pair)
    return torch.nn.functional.pad(x, flat)

kernel_name = 'parallel_sum__gqa_block_cached__dense_activation_gelu__decode'

def setup_inputs():

    _w = (lambda a: (lambda t: t.to(torch.bfloat16) if t.is_floating_point() else t)(torch.as_tensor(a)))
    def _A_setup():
        B, Sq, D = 2, 1, 512
        Hq, Hkv, Sk, Dh = 32, 8, 8192, 128
        assert Hq % Hkv == 0, (Hq, Hkv)
        return {
            "x": _w((lambda *s: torch.randn(*s, dtype=torch.bfloat16) * 0.05)(B, Sq, D)),
            "k_cache": _w((lambda *s: torch.randn(*s, dtype=torch.bfloat16) * 1.6)(B, Hkv, Sk, Dh)),
            "v_cache": _w((lambda *s: torch.randn(*s, dtype=torch.bfloat16) * 0.8)(B, Hkv, Sk, Dh)),
            "wq": _w((lambda *s: torch.randn(*s, dtype=torch.bfloat16) * 1.6)(D, Hq * Dh) * (D ** -0.5)),
            "wo": _w((lambda *s: torch.randn(*s, dtype=torch.bfloat16) * 0.8)(Hq * Dh, D) * ((Hq * Dh) ** -0.5)),
        }
    _A_in = _A_setup()

    def _B_setup():
        B, S, D, F = 2, 1, 512, 1792
        return {
            "x": _w((lambda *s: torch.randn(*s, dtype=torch.bfloat16) * 0.05)(B, S, D)),
            "w1": _w((lambda *s: torch.randn(*s, dtype=torch.bfloat16) * 0.4)(D, F) * (D ** -0.5)),
            "b1": _w((lambda *s: torch.randn(*s, dtype=torch.bfloat16) * 0.4)(F) * 0.01),
            "w2": _w((lambda *s: torch.randn(*s, dtype=torch.bfloat16) * 0.4)(F, D) * (F ** -0.5)),
            "b2": _w((lambda *s: torch.randn(*s, dtype=torch.bfloat16) * 0.4)(D) * 0.01),
        }
    _B_in = _B_setup()

    return {
        "A_x": _A_in["x"],
        "A_k_cache": _A_in["k_cache"],
        "A_v_cache": _A_in["v_cache"],
        "A_wq": _A_in["wq"],
        "A_wo": _A_in["wo"],
        "B_x": _B_in["x"],
        "B_w1": _B_in["w1"],
        "B_b1": _B_in["b1"],
        "B_w2": _B_in["w2"],
        "B_b2": _B_in["b2"],
    }

def reference(A_x, A_k_cache, A_v_cache, A_wq, A_wo, B_x, B_w1, B_b1, B_w2, B_b2):
    def _A_ref(x, k_cache, v_cache, wq, wo):
        B, Sq, D = x.shape
        Hq, Dh = 32, 128
        Hkv = k_cache.shape[1]
        rep = Hq // Hkv
        q = (lambda x, *d: x.permute(*d))((x @ wq).reshape(B, Sq, Hq, Dh), 0, 2, 1, 3)
        k = (lambda x, n, axis: torch.repeat_interleave(x, n, dim=axis))(k_cache, rep, axis=1)
        v = (lambda x, n, axis: torch.repeat_interleave(x, n, dim=axis))(v_cache, rep, axis=1)
        scores = torch.einsum("bhqd,bhkd->bhqk", q, k) * (Dh ** -0.5)
        p = _softmax(scores, axis=-1)
        o = torch.einsum("bhqk,bhkd->bhqd", p, v)
        return (lambda x, *d: x.permute(*d))(o, 0, 2, 1, 3).reshape(B, Sq, Hq * Dh) @ wo

    def _B_ref(x, w1, b1, w2, b2):
        h = torch.einsum("bsd,df->bsf", x, w1) + b1
        h = _gelu(h)
        return torch.einsum("bsf,fd->bsd", h, w2) + b2

    x = A_x
    xn = _layernorm(x, axis=-1)
    return x + _A_ref(xn, A_k_cache, A_v_cache, A_wq, A_wo) + _B_ref(xn, B_w1, B_b1, B_w2, B_b2)
```

```asm
; @launch grid=(256,1,1) block=(768,1,1) lds=137984
.amdgcn_target "amdgcn-amd-amdhsa--gfx950"
.text
.globl parallel_sum__gqa_block_cached__dense_activation_gelu__decode_kernel
.p2align 8
.type parallel_sum__gqa_block_cached__dense_activation_gelu__decode_kernel,@function
parallel_sum__gqa_block_cached__dense_activation_gelu__decode_kernel:
    s_cmp_ge_u32 s2, 256
    s_cbranch_scc1 L_exit
    s_load_dwordx16 s[16:31], s[0:1], 0
    s_load_dwordx8 s[32:39], s[0:1], 64
    s_load_dwordx2 s[40:41], s[0:1], 96
    v_lshrrev_b32 v4, 6, v0
    v_and_b32 v0, 63, v0
    v_readfirstlane_b32 s3, v4
    v_and_b32 v2, 15, v0
    v_lshrrev_b32 v3, 4, v0
    s_mov_b32 s95, s3
    s_lshr_b32 s6, s2, 7
    s_bfe_u32 s4, s2, 0x30004
    s_and_b32 s7, s2, 15
    s_mov_b32 s92, 0x05040100
    s_mov_b32 s93, 0x07060302
    s_cmp_lt_u32 s3, 4
    s_cbranch_scc1 L_helpers
    s_sub_u32 s3, s3, 4
    v_add_u32 v8, 0, v3
    v_xor_b32 v8, v8, v2
    v_lshlrev_b32 v8, 4, v8
    v_lshlrev_b32 v9, 8, v3
    v_add_u32 v4, v8, v9
    v_add_u32 v8, 4, v3
    v_xor_b32 v8, v8, v2
    v_lshlrev_b32 v8, 4, v8
    v_lshlrev_b32 v9, 8, v3
    v_add_u32 v5, v8, v9
    v_add_u32 v8, 8, v3
    v_xor_b32 v8, v8, v2
    v_lshlrev_b32 v8, 4, v8
    v_lshlrev_b32 v9, 8, v3
    v_add_u32 v6, v8, v9
    v_add_u32 v8, 12, v3
    v_xor_b32 v8, v8, v2
    v_lshlrev_b32 v8, 4, v8
    v_lshlrev_b32 v9, 8, v3
    v_add_u32 v7, v8, v9
    s_mul_i32 s8, s3, 16384
    s_lshl_b32 s14, s3, 12
    s_lshl_b32 s9, s7, 15
    s_add_u32 s14, s14, s9
    s_lshr_b32 s9, s2, 4
    s_lshl_b32 s9, s9, 21
    s_mov_b32 s5, 0
    s_waitcnt lgkmcnt(0)
    s_load_dwordx2 s[22:23], s[38:39], 0
    s_add_u32 s18, s18, s9
    s_addc_u32 s19, s19, 0
    s_mov_b32 s44, s18
    s_and_b32 s45, s19, 0xffff
    s_mov_b32 s46, 2097152
    s_mov_b32 s47, 0x20000
    v_mov_b32 v13, 131104
    s_add_u32 s9, s8, 0
    s_mov_b32 m0, s9
    s_add_u32 s9, s14, 0
    buffer_load_dwordx4 v4, s[44:47], s9 offen offset:0 nt lds
    buffer_load_dwordx4 v5, s[44:47], s9 offen offset:1024 nt lds
    buffer_load_dwordx4 v6, s[44:47], s9 offen offset:2048 nt lds
    s_barrier
    s_lshr_b32 s9, s2, 4
    s_lshl_b32 s9, s9, 21
    s_add_u32 s20, s20, s9
    s_addc_u32 s21, s21, 0
    s_mov_b32 s48, s20
    s_and_b32 s49, s21, 0xffff
    s_mov_b32 s50, 2097152
    s_mov_b32 s51, 0x20000
    s_add_u32 s9, s14, 0
    s_cmp_eq_u32 s5, 2
    s_cbranch_scc1 L_pc3
    s_cmp_lg_u32 s5, 0
    s_cbranch_scc1 L_pc3
    s_waitcnt vmcnt(2)
L_pc3:
    buffer_load_dwordx4 v7, s[44:47], s9 offen offset:3072 nt lds
    s_cmp_eq_u32 s5, 2
    s_cbranch_scc1 L_pc4
    s_cmp_lg_u32 s5, 0
    s_cbranch_scc1 L_pc4
    s_waitcnt vmcnt(2)
L_pc4:
    ds_read_b32 v12, v13
    s_memrealtime s[10:11]
    s_waitcnt lgkmcnt(0)
    v_readfirstlane_b32 s12, v12
    s_nop 0
    s_cmp_eq_u32 s12, 0
    s_cselect_b32 s12, s22, s12
    s_sub_u32 s13, s10, s12
    s_cmp_gt_u32 s13, 228
    s_cselect_b32 s5, 1, 0
    s_cmp_gt_u32 s13, 348
    s_cselect_b32 s5, 2, s5
    s_cmp_eq_u32 s12, 0
    s_cselect_b32 s5, 0, s5
    s_add_u32 s9, s8, 4096
    s_mov_b32 m0, s9
    s_add_u32 s9, s14, 524288
    buffer_load_dwordx4 v4, s[44:47], s9 offen offset:0 nt lds
    s_cmp_eq_u32 s5, 2
    s_cbranch_scc1 L_pc5
    s_cmp_lg_u32 s5, 0
    s_cbranch_scc1 L_pc5
    s_waitcnt vmcnt(2)
L_pc5:
    buffer_load_dwordx4 v5, s[44:47], s9 offen offset:1024 nt lds
    s_cmp_eq_u32 s5, 2
    s_cbranch_scc1 L_pc6
    s_waitcnt vmcnt(5)
    s_cmp_lg_u32 s5, 0
    s_cbranch_scc1 L_pc6
    s_waitcnt vmcnt(2)
L_pc6:
    buffer_load_dwordx4 v6, s[44:47], s9 offen offset:2048 nt lds
    s_cmp_eq_u32 s5, 2
    s_cbranch_scc1 L_pc7
    s_waitcnt vmcnt(5)
    s_cmp_lg_u32 s5, 0
    s_cbranch_scc1 L_pc7
    s_waitcnt vmcnt(2)
L_pc7:
    buffer_load_dwordx4 v7, s[44:47], s9 offen offset:3072 nt lds
    s_cmp_eq_u32 s5, 2
    s_cbranch_scc1 L_pc8
    s_waitcnt vmcnt(5)
    s_cmp_lg_u32 s5, 0
    s_cbranch_scc1 L_pc8
    s_waitcnt vmcnt(2)
L_pc8:
    ds_read_b32 v12, v13
    s_memrealtime s[10:11]
    s_waitcnt lgkmcnt(0)
    v_readfirstlane_b32 s12, v12
    s_nop 0
    s_cmp_eq_u32 s12, 0
    s_cselect_b32 s12, s22, s12
    s_sub_u32 s13, s10, s12
    s_cmp_gt_u32 s13, 376
    s_cselect_b32 s5, 1, 0
    s_cmp_gt_u32 s13, 496
    s_cselect_b32 s5, 2, s5
    s_cmp_eq_u32 s12, 0
    s_cselect_b32 s5, 0, s5
    s_add_u32 s9, s8, 8192
    s_mov_b32 m0, s9
    s_add_u32 s9, s14, 1048576
    buffer_load_dwordx4 v4, s[44:47], s9 offen offset:0 nt lds
    s_cmp_eq_u32 s5, 2
    s_cbranch_scc1 L_pc9
    s_waitcnt vmcnt(5)
    s_cmp_lg_u32 s5, 0
    s_cbranch_scc1 L_pc9
    s_waitcnt vmcnt(2)
L_pc9:
    buffer_load_dwordx4 v5, s[44:47], s9 offen offset:1024 nt lds
    s_cmp_eq_u32 s5, 2
    s_cbranch_scc1 L_pc10
    s_waitcnt vmcnt(5)
    s_cmp_lg_u32 s5, 0
    s_cbranch_scc1 L_pc10
    s_waitcnt vmcnt(2)
L_pc10:
    buffer_load_dwordx4 v6, s[44:47], s9 offen offset:2048 nt lds
    s_cmp_eq_u32 s5, 2
    s_cbranch_scc1 L_pc11
    s_waitcnt vmcnt(5)
    s_cmp_lg_u32 s5, 0
    s_cbranch_scc1 L_pc11
    s_waitcnt vmcnt(2)
L_pc11:
    buffer_load_dwordx4 v7, s[44:47], s9 offen offset:3072 nt lds
    s_waitcnt vmcnt(11)
    s_cmp_eq_u32 s5, 2
    s_cbranch_scc1 L_pc12
    s_waitcnt vmcnt(5)
    s_cmp_lg_u32 s5, 0
    s_cbranch_scc1 L_pc12
    s_waitcnt vmcnt(2)
L_pc12:
    ds_read_b32 v12, v13
    s_memrealtime s[10:11]
    s_waitcnt lgkmcnt(0)
    v_readfirstlane_b32 s12, v12
    s_nop 0
    s_cmp_eq_u32 s12, 0
    s_cselect_b32 s12, s22, s12
    s_sub_u32 s13, s10, s12
    s_cmp_gt_u32 s13, 524
    s_cselect_b32 s5, 1, 0
    s_cmp_gt_u32 s13, 644
    s_cselect_b32 s5, 2, s5
    s_cmp_eq_u32 s12, 0
    s_cselect_b32 s5, 0, s5
    s_add_u32 s9, s8, 12288
    s_mov_b32 m0, s9
    s_add_u32 s9, s14, 1572864
    buffer_load_dwordx4 v4, s[44:47], s9 offen offset:0 nt lds
    s_waitcnt vmcnt(11)
    s_cmp_eq_u32 s5, 2
    s_cbranch_scc1 L_pc13
    s_waitcnt vmcnt(5)
    s_cmp_lg_u32 s5, 0
    s_cbranch_scc1 L_pc13
    s_waitcnt vmcnt(2)
L_pc13:
    buffer_load_dwordx4 v5, s[44:47], s9 offen offset:1024 nt lds
    s_waitcnt vmcnt(11)
    s_cmp_eq_u32 s5, 2
    s_cbranch_scc1 L_pc14
    s_waitcnt vmcnt(5)
    s_cmp_lg_u32 s5, 0
    s_cbranch_scc1 L_pc14
    s_waitcnt vmcnt(2)
L_pc14:
    buffer_load_dwordx4 v6, s[44:47], s9 offen offset:2048 nt lds
    s_waitcnt vmcnt(11)
    s_cmp_eq_u32 s5, 2
    s_cbranch_scc1 L_pc15
    s_waitcnt vmcnt(5)
    s_cmp_lg_u32 s5, 0
    s_cbranch_scc1 L_pc15
    s_waitcnt vmcnt(2)
L_pc15:
    buffer_load_dwordx4 v7, s[44:47], s9 offen offset:3072 nt lds
    s_waitcnt vmcnt(11)
    s_cmp_eq_u32 s5, 2
    s_cbranch_scc1 L_pc16
    s_waitcnt vmcnt(5)
    s_cmp_lg_u32 s5, 0
    s_cbranch_scc1 L_pc16
    s_waitcnt vmcnt(2)
L_pc16:
    ds_read_b32 v12, v13
    s_memrealtime s[10:11]
    s_waitcnt lgkmcnt(0)
    v_readfirstlane_b32 s12, v12
    s_nop 0
    s_cmp_eq_u32 s12, 0
    s_cselect_b32 s12, s22, s12
    s_sub_u32 s13, s10, s12
    s_cmp_gt_u32 s13, 672
    s_cselect_b32 s5, 1, 0
    s_cmp_gt_u32 s13, 792
    s_cselect_b32 s5, 2, s5
    s_cmp_eq_u32 s12, 0
    s_cselect_b32 s5, 0, s5
    v_mov_b32 v11, 131116
    v_mov_b32 v12, 1
    s_mov_b64 s[98:99], exec
    s_mov_b64 exec, 1
    ds_add_u32 v11, v12
    s_mov_b64 exec, s[98:99]
    v_lshlrev_b32 v8, 10, v3
    v_lshlrev_b32 v9, 4, v2
    v_add_u32 v8, v8, v9
    v_add_u32 v9, 0, v3
    v_xor_b32 v9, v9, v2
    v_lshlrev_b32 v9, 4, v9
    v_lshlrev_b32 v10, 8, v2
    v_add_u32 v9, v9, v10
    v_add_u32 v4, s8, v9
    v_add_u32 v9, 4, v3
    v_xor_b32 v9, v9, v2
    v_lshlrev_b32 v9, 4, v9
    v_lshlrev_b32 v10, 8, v2
    v_add_u32 v9, v9, v10
    v_add_u32 v5, s8, v9
    v_add_u32 v9, 8, v3
    v_xor_b32 v9, v9, v2
    v_lshlrev_b32 v9, 4, v9
    v_lshlrev_b32 v10, 8, v2
    v_add_u32 v9, v9, v10
    v_add_u32 v6, s8, v9
    v_add_u32 v9, 12, v3
    v_xor_b32 v9, v9, v2
    v_lshlrev_b32 v9, 4, v9
    v_lshlrev_b32 v10, 8, v2
    v_add_u32 v9, v9, v10
    v_add_u32 v7, s8, v9
    v_lshrrev_b32 v10, 2, v2
    v_mul_u32_u24 v9, 272, v10
    v_lshlrev_b32 v11, 4, v3
    v_add_u32 v9, v9, v11
    v_add_u32 v9, 131136, v9
    v_lshlrev_b32 v10, 2, v10
    v_add_u32 v10, 131072, v10
    v_mov_b32 v14, 131088
    s_mov_b32 s24, 0x3db504f3
    s_mov_b32 s25, 0x3db504f3
    v_mov_b32 v56, 0x3f803f80
    v_mov_b32 v57, 0x3f803f80
    v_mov_b32 v58, 0x3f803f80
    v_mov_b32 v59, 0x3f803f80
    v_mov_b32 v32, 0
    v_mov_b32 v33, 0
    v_mov_b32 v34, 0
    v_mov_b32 v35, 0
    v_mov_b32 v36, 0
    v_mov_b32 v37, 0
    v_mov_b32 v38, 0
    v_mov_b32 v39, 0
    v_mov_b32 v40, 0
    v_mov_b32 v41, 0
    v_mov_b32 v42, 0
    v_mov_b32 v43, 0
    v_mov_b32 v44, 0
    v_mov_b32 v45, 0
    v_mov_b32 v46, 0
    v_mov_b32 v47, 0
    s_add_u32 s15, s14, 0
    buffer_load_dwordx4 v[64:67], v8, s[48:51], s15 offen offset:0 nt
    s_waitcnt vmcnt(11)
    s_cmp_eq_u32 s5, 2
    s_cbranch_scc1 L_pc17
    s_waitcnt vmcnt(5)
    s_cmp_lg_u32 s5, 0
    s_cbranch_scc1 L_pc17
    s_waitcnt vmcnt(2)
L_pc17:
    buffer_load_dwordx4 v[68:71], v8, s[48:51], s15 offen offset:256 nt
    s_waitcnt vmcnt(11)
    s_cmp_eq_u32 s5, 2
    s_cbranch_scc1 L_pc18
    s_waitcnt vmcnt(5)
    s_cmp_lg_u32 s5, 0
    s_cbranch_scc1 L_pc18
    s_waitcnt vmcnt(2)
L_pc18:
    buffer_load_dwordx4 v[72:75], v8, s[48:51], s15 offen offset:512 nt
    s_waitcnt vmcnt(11)
    s_cmp_eq_u32 s5, 2
    s_cbranch_scc1 L_pc19
    s_waitcnt vmcnt(5)
    s_cmp_lg_u32 s5, 0
    s_cbranch_scc1 L_pc19
    s_waitcnt vmcnt(2)
L_pc19:
    buffer_load_dwordx4 v[76:79], v8, s[48:51], s15 offen offset:768 nt
    s_waitcnt vmcnt(11)
    s_cmp_eq_u32 s5, 2
    s_cbranch_scc1 L_pc20
    s_waitcnt vmcnt(5)
    s_cmp_lg_u32 s5, 0
    s_cbranch_scc1 L_pc20
    s_waitcnt vmcnt(2)
L_pc20:
    ds_read_b32 v12, v13
    s_memrealtime s[10:11]
    s_waitcnt lgkmcnt(0)
    v_readfirstlane_b32 s12, v12
    s_nop 0
    s_cmp_eq_u32 s12, 0
    s_cselect_b32 s12, s22, s12
    s_sub_u32 s13, s10, s12
    s_cmp_gt_u32 s13, 786
    s_cselect_b32 s5, 1, 0
    s_cmp_gt_u32 s13, 906
    s_cselect_b32 s5, 2, s5
    s_cmp_eq_u32 s12, 0
    s_cselect_b32 s5, 0, s5
    s_add_u32 s15, s14, 524288
    buffer_load_dwordx4 v[80:83], v8, s[48:51], s15 offen offset:0 nt
    s_waitcnt vmcnt(11)
    s_cmp_eq_u32 s5, 2
    s_cbranch_scc1 L_pc21
    s_waitcnt vmcnt(5)
    s_cmp_lg_u32 s5, 0
    s_cbranch_scc1 L_pc21
    s_waitcnt vmcnt(2)
L_pc21:
    buffer_load_dwordx4 v[84:87], v8, s[48:51], s15 offen offset:256 nt
    s_waitcnt vmcnt(11)
    s_cmp_eq_u32 s5, 2
    s_cbranch_scc1 L_pc22
    s_waitcnt vmcnt(5)
    s_cmp_lg_u32 s5, 0
    s_cbranch_scc1 L_pc22
    s_waitcnt vmcnt(2)
L_pc22:
    buffer_load_dwordx4 v[88:91], v8, s[48:51], s15 offen offset:512 nt
    s_waitcnt vmcnt(11)
    s_cmp_eq_u32 s5, 2
    s_cbranch_scc1 L_pc23
    s_waitcnt vmcnt(5)
    s_cmp_lg_u32 s5, 0
    s_cbranch_scc1 L_pc23
    s_waitcnt vmcnt(2)
L_pc23:
    buffer_load_dwordx4 v[92:95], v8, s[48:51], s15 offen offset:768 nt
    s_waitcnt vmcnt(11)
    s_cmp_eq_u32 s5, 2
    s_cbranch_scc1 L_pc24
    s_waitcnt vmcnt(5)
    s_cmp_lg_u32 s5, 0
    s_cbranch_scc1 L_pc24
    s_waitcnt vmcnt(2)
L_pc24:
    ds_read_b32 v12, v13
    s_memrealtime s[10:11]
    s_waitcnt lgkmcnt(0)
    v_readfirstlane_b32 s12, v12
    s_nop 0
    s_cmp_eq_u32 s12, 0
    s_cselect_b32 s12, s22, s12
    s_sub_u32 s13, s10, s12
    s_cmp_gt_u32 s13, 902
    s_cselect_b32 s5, 1, 0
    s_cmp_gt_u32 s13, 1022
    s_cselect_b32 s5, 2, s5
    s_cmp_eq_u32 s12, 0
    s_cselect_b32 s5, 0, s5
    s_add_u32 s15, s14, 1048576
    buffer_load_dwordx4 v[96:99], v8, s[48:51], s15 offen offset:0 nt
    s_waitcnt vmcnt(11)
    s_cmp_eq_u32 s5, 2
    s_cbranch_scc1 L_pc25
    s_waitcnt vmcnt(5)
    s_cmp_lg_u32 s5, 0
    s_cbranch_scc1 L_pc25
    s_waitcnt vmcnt(2)
L_pc25:
    buffer_load_dwordx4 v[100:103], v8, s[48:51], s15 offen offset:256 nt
    s_waitcnt vmcnt(11)
    s_cmp_eq_u32 s5, 2
    s_cbranch_scc1 L_pc26
    s_waitcnt vmcnt(5)
    s_cmp_lg_u32 s5, 0
    s_cbranch_scc1 L_pc26
    s_waitcnt vmcnt(2)
L_pc26:
    ds_read_b32 v12, v14
    s_waitcnt lgkmcnt(0)
    v_readfirstlane_b32 s9, v12
    s_nop 0
    s_cmp_eq_u32 s9, 0
    s_cbranch_scc1 L_pathB
    buffer_load_dwordx4 v[104:107], v8, s[48:51], s15 offen offset:512 nt
    s_waitcnt vmcnt(11)
    s_cmp_eq_u32 s5, 2
    s_cbranch_scc1 L_pc27a
    s_waitcnt vmcnt(5)
    s_cmp_lg_u32 s5, 0
    s_cbranch_scc1 L_pc27a
    s_waitcnt vmcnt(2)
L_pc27a:
    s_waitcnt vmcnt(11)
    ds_read_b128 v[16:19], v9 offset:0
    ds_read_b128 v[20:23], v9 offset:64
    ds_read_b128 v[24:27], v9 offset:128
    ds_read_b128 v[28:31], v9 offset:192
    ds_read_b128 v[128:131], v4 offset:0
    ds_read_b128 v[132:135], v5 offset:0
    ds_read_b128 v[136:139], v6 offset:0
    ds_read_b128 v[140:143], v7 offset:0
    buffer_load_dwordx4 v[108:111], v8, s[48:51], s15 offen offset:768 nt
    s_waitcnt vmcnt(11)
    s_cmp_eq_u32 s5, 2
    s_cbranch_scc1 L_pc28a
    s_waitcnt vmcnt(5)
    s_cmp_lg_u32 s5, 0
    s_cbranch_scc1 L_pc28a
    s_waitcnt vmcnt(2)
L_pc28a:
    ds_read_b128 v[144:147], v4 offset:4096
    ds_read_b128 v[148:151], v5 offset:4096
    ds_read_b128 v[152:155], v6 offset:4096
    ds_read_b128 v[156:159], v7 offset:4096
    s_waitcnt lgkmcnt(4)
    v_mfma_f32_16x16x32_bf16 v[32:35], v[128:131], v[16:19], v[32:35]
    v_mfma_f32_16x16x32_bf16 v[32:35], v[132:135], v[20:23], v[32:35]
    v_mfma_f32_16x16x32_bf16 v[32:35], v[136:139], v[24:27], v[32:35]
    v_mfma_f32_16x16x32_bf16 v[32:35], v[140:143], v[28:31], v[32:35]
    s_add_u32 s15, s14, 1572864
    buffer_load_dwordx4 v[112:115], v8, s[48:51], s15 offen offset:0 nt
    s_waitcnt vmcnt(11)
    s_cmp_eq_u32 s5, 2
    s_cbranch_scc1 L_pc29a
    s_waitcnt vmcnt(5)
    s_cmp_lg_u32 s5, 0
    s_cbranch_scc1 L_pc29a
    s_waitcnt vmcnt(2)
L_pc29a:
    ds_read_b128 v[128:131], v4 offset:8192
    ds_read_b128 v[132:135], v5 offset:8192
    ds_read_b128 v[136:139], v6 offset:8192
    ds_read_b128 v[140:143], v7 offset:8192
    s_waitcnt lgkmcnt(4)
    v_mfma_f32_16x16x32_bf16 v[36:39], v[144:147], v[16:19], v[36:39]
    v_mfma_f32_16x16x32_bf16 v[36:39], v[148:151], v[20:23], v[36:39]
    v_mfma_f32_16x16x32_bf16 v[36:39], v[152:155], v[24:27], v[36:39]
    v_mfma_f32_16x16x32_bf16 v[36:39], v[156:159], v[28:31], v[36:39]
    v_cvt_pk_bf16_f32 v11, v32, v33
    v_lshlrev_b32 v32, 16, v11
    v_and_b32 v33, 0xffff0000, v11
    v_pk_mul_f32 v[32:33], v[32:33], s[24:25]
    v_cvt_pk_bf16_f32 v11, v32, v33
    v_lshlrev_b32 v32, 16, v11
    v_and_b32 v33, 0xffff0000, v11
    v_cvt_pk_bf16_f32 v11, v34, v35
    v_lshlrev_b32 v34, 16, v11
    v_and_b32 v35, 0xffff0000, v11
    v_pk_mul_f32 v[34:35], v[34:35], s[24:25]
    v_cvt_pk_bf16_f32 v11, v34, v35
    v_lshlrev_b32 v34, 16, v11
    v_and_b32 v35, 0xffff0000, v11
    buffer_load_dwordx4 v[116:119], v8, s[48:51], s15 offen offset:256 nt
    s_waitcnt vmcnt(11)
    s_cmp_eq_u32 s5, 2
    s_cbranch_scc1 L_pc30a
    s_waitcnt vmcnt(5)
    s_cmp_lg_u32 s5, 0
    s_cbranch_scc1 L_pc30a
    s_waitcnt vmcnt(2)
L_pc30a:
    ds_read_b128 v[144:147], v4 offset:12288
    ds_read_b128 v[148:151], v5 offset:12288
    ds_read_b128 v[152:155], v6 offset:12288
    ds_read_b128 v[156:159], v7 offset:12288
    s_waitcnt lgkmcnt(4)
    v_mfma_f32_16x16x32_bf16 v[40:43], v[128:131], v[16:19], v[40:43]
    v_mfma_f32_16x16x32_bf16 v[40:43], v[132:135], v[20:23], v[40:43]
    v_mfma_f32_16x16x32_bf16 v[40:43], v[136:139], v[24:27], v[40:43]
    v_mfma_f32_16x16x32_bf16 v[40:43], v[140:143], v[28:31], v[40:43]
    v_cvt_pk_bf16_f32 v11, v36, v37
    v_lshlrev_b32 v36, 16, v11
    v_and_b32 v37, 0xffff0000, v11
    v_pk_mul_f32 v[36:37], v[36:37], s[24:25]
    v_cvt_pk_bf16_f32 v11, v36, v37
    v_lshlrev_b32 v36, 16, v11
    v_and_b32 v37, 0xffff0000, v11
    v_cvt_pk_bf16_f32 v11, v38, v39
    v_lshlrev_b32 v38, 16, v11
    v_and_b32 v39, 0xffff0000, v11
    v_pk_mul_f32 v[38:39], v[38:39], s[24:25]
    v_cvt_pk_bf16_f32 v11, v38, v39
    v_lshlrev_b32 v38, 16, v11
    v_and_b32 v39, 0xffff0000, v11
    buffer_load_dwordx4 v[120:123], v8, s[48:51], s15 offen offset:512 nt
    s_waitcnt vmcnt(11)
    s_cmp_eq_u32 s5, 2
    s_cbranch_scc1 L_pc31a
    s_waitcnt vmcnt(5)
    s_cmp_lg_u32 s5, 0
    s_cbranch_scc1 L_pc31a
    s_waitcnt vmcnt(2)
L_pc31a:
    s_waitcnt lgkmcnt(0)
    v_mfma_f32_16x16x32_bf16 v[44:47], v[144:147], v[16:19], v[44:47]
    v_mfma_f32_16x16x32_bf16 v[44:47], v[148:151], v[20:23], v[44:47]
    v_mfma_f32_16x16x32_bf16 v[44:47], v[152:155], v[24:27], v[44:47]
    v_mfma_f32_16x16x32_bf16 v[44:47], v[156:159], v[28:31], v[44:47]
    v_cvt_pk_bf16_f32 v11, v40, v41
    v_lshlrev_b32 v40, 16, v11
    v_and_b32 v41, 0xffff0000, v11
    v_pk_mul_f32 v[40:41], v[40:41], s[24:25]
    v_cvt_pk_bf16_f32 v11, v40, v41
    v_lshlrev_b32 v40, 16, v11
    v_and_b32 v41, 0xffff0000, v11
    v_cvt_pk_bf16_f32 v11, v42, v43
    v_lshlrev_b32 v42, 16, v11
    v_and_b32 v43, 0xffff0000, v11
    v_pk_mul_f32 v[42:43], v[42:43], s[24:25]
    v_cvt_pk_bf16_f32 v11, v42, v43
    v_lshlrev_b32 v42, 16, v11
    v_and_b32 v43, 0xffff0000, v11
    v_cvt_pk_bf16_f32 v11, v44, v45
    v_lshlrev_b32 v44, 16, v11
    v_and_b32 v45, 0xffff0000, v11
    v_pk_mul_f32 v[44:45], v[44:45], s[24:25]
    v_cvt_pk_bf16_f32 v11, v44, v45
    v_lshlrev_b32 v44, 16, v11
    v_and_b32 v45, 0xffff0000, v11
    v_cvt_pk_bf16_f32 v11, v46, v47
    v_lshlrev_b32 v46, 16, v11
    v_and_b32 v47, 0xffff0000, v11
    v_pk_mul_f32 v[46:47], v[46:47], s[24:25]
    v_cvt_pk_bf16_f32 v11, v46, v47
    v_lshlrev_b32 v46, 16, v11
    v_and_b32 v47, 0xffff0000, v11
    v_max3_f32 v12, v32, v33, v34
    v_max3_f32 v12, v12, v35, v36
    v_max3_f32 v12, v12, v37, v38
    v_max3_f32 v12, v12, v39, v40
    v_max3_f32 v12, v12, v41, v42
    v_max_f32 v12, v12, v43
    v_max3_f32 v11, v44, v45, v46
    v_max3_f32 v12, v12, v11, v47
    v_mov_b32 v11, v12
    s_nop 1
    v_permlane16_swap_b32 v12, v11
    v_max_f32 v12, v12, v11
    v_mov_b32 v11, v12
    s_nop 1
    v_permlane32_swap_b32 v12, v11
    v_max_f32 v12, v12, v11
    ds_max_f32 v10, v12
    v_mov_b32 v11, 131120
    v_mov_b32 v15, 1
    s_mov_b64 s[98:99], exec
    s_mov_b64 exec, 1
    ds_add_u32 v11, v15
    s_mov_b64 exec, s[98:99]
    v_mov_b32 v15, v12
    buffer_load_dwordx4 v[124:127], v8, s[48:51], s15 offen offset:768 nt
    v_mov_b32 v11, 131092
    v_mov_b32 v12, 1
    s_mov_b64 s[98:99], exec
    s_mov_b64 exec, 1
    ds_add_u32 v11, v12
    s_mov_b64 exec, s[98:99]
    s_branch L_qkdone
L_pathB:
    s_nop 1
    buffer_load_dwordx4 v[104:107], v8, s[48:51], s15 offen offset:512 nt
    s_waitcnt vmcnt(11)
    s_cmp_eq_u32 s5, 2
    s_cbranch_scc1 L_pc27b
    s_waitcnt vmcnt(5)
    s_cmp_lg_u32 s5, 0
    s_cbranch_scc1 L_pc27b
    s_waitcnt vmcnt(2)
L_pc27b:
    buffer_load_dwordx4 v[108:111], v8, s[48:51], s15 offen offset:768 nt
    s_waitcnt vmcnt(11)
    s_cmp_eq_u32 s5, 2
    s_cbranch_scc1 L_pc28b
    s_waitcnt vmcnt(5)
    s_cmp_lg_u32 s5, 0
    s_cbranch_scc1 L_pc28b
    s_waitcnt vmcnt(2)
L_pc28b:
    s_add_u32 s15, s14, 1572864
    buffer_load_dwordx4 v[112:115], v8, s[48:51], s15 offen offset:0 nt
    s_waitcnt vmcnt(11)
    s_cmp_eq_u32 s5, 2
    s_cbranch_scc1 L_pc29b
    s_waitcnt vmcnt(5)
    s_cmp_lg_u32 s5, 0
    s_cbranch_scc1 L_pc29b
    s_waitcnt vmcnt(2)
L_pc29b:
    buffer_load_dwordx4 v[116:119], v8, s[48:51], s15 offen offset:256 nt
    s_waitcnt vmcnt(11)
    s_cmp_eq_u32 s5, 2
    s_cbranch_scc1 L_pc30b
    s_waitcnt vmcnt(5)
    s_cmp_lg_u32 s5, 0
    s_cbranch_scc1 L_pc30b
    s_waitcnt vmcnt(2)
L_pc30b:
    buffer_load_dwordx4 v[120:123], v8, s[48:51], s15 offen offset:512 nt
    s_waitcnt vmcnt(11)
    s_cmp_eq_u32 s5, 2
    s_cbranch_scc1 L_pc31b
    s_waitcnt vmcnt(5)
    s_cmp_lg_u32 s5, 0
    s_cbranch_scc1 L_pc31b
    s_waitcnt vmcnt(2)
L_pc31b:
    buffer_load_dwordx4 v[124:127], v8, s[48:51], s15 offen offset:768 nt
    v_mov_b32 v11, 131092
    v_mov_b32 v12, 1
    s_mov_b64 s[98:99], exec
    s_mov_b64 exec, 1
    ds_add_u32 v11, v12
    s_mov_b64 exec, s[98:99]
    s_mov_b32 s94, 0
L_qw:
    ds_read_b32 v12, v14
    s_add_u32 s94, s94, 1
    s_waitcnt lgkmcnt(0)
    v_readfirstlane_b32 s9, v12
    s_cmp_gt_u32 s94, 4000000
    s_cbranch_scc1 L_qw_go
    s_cmp_ge_u32 s9, 1
    s_cbranch_scc1 L_qw_go
    s_sleep 1
    s_branch L_qw
L_qw_go:
    s_waitcnt vmcnt(16)
    ds_read_b128 v[16:19], v9 offset:0
    ds_read_b128 v[20:23], v9 offset:64
    ds_read_b128 v[24:27], v9 offset:128
    ds_read_b128 v[28:31], v9 offset:192
    ds_read_b128 v[128:131], v4 offset:0
    ds_read_b128 v[132:135], v5 offset:0
    ds_read_b128 v[136:139], v6 offset:0
    ds_read_b128 v[140:143], v7 offset:0
    ds_read_b128 v[144:147], v4 offset:4096
    ds_read_b128 v[148:151], v5 offset:4096
    ds_read_b128 v[152:155], v6 offset:4096
    ds_read_b128 v[156:159], v7 offset:4096
    s_waitcnt lgkmcnt(4)
    v_mfma_f32_16x16x32_bf16 v[32:35], v[128:131], v[16:19], v[32:35]
    v_mfma_f32_16x16x32_bf16 v[32:35], v[132:135], v[20:23], v[32:35]
    v_mfma_f32_16x16x32_bf16 v[32:35], v[136:139], v[24:27], v[32:35]
    v_mfma_f32_16x16x32_bf16 v[32:35], v[140:143], v[28:31], v[32:35]
    ds_read_b128 v[128:131], v4 offset:8192
    ds_read_b128 v[132:135], v5 offset:8192
    ds_read_b128 v[136:139], v6 offset:8192
    ds_read_b128 v[140:143], v7 offset:8192
    s_waitcnt lgkmcnt(4)
    v_mfma_f32_16x16x32_bf16 v[36:39], v[144:147], v[16:19], v[36:39]
    v_mfma_f32_16x16x32_bf16 v[36:39], v[148:151], v[20:23], v[36:39]
    v_mfma_f32_16x16x32_bf16 v[36:39], v[152:155], v[24:27], v[36:39]
    v_mfma_f32_16x16x32_bf16 v[36:39], v[156:159], v[28:31], v[36:39]
    v_cvt_pk_bf16_f32 v11, v32, v33
    v_lshlrev_b32 v32, 16, v11
    v_and_b32 v33, 0xffff0000, v11
    v_pk_mul_f32 v[32:33], v[32:33], s[24:25]
    v_cvt_pk_bf16_f32 v11, v32, v33
    v_lshlrev_b32 v32, 16, v11
    v_and_b32 v33, 0xffff0000, v11
    v_cvt_pk_bf16_f32 v11, v34, v35
    v_lshlrev_b32 v34, 16, v11
    v_and_b32 v35, 0xffff0000, v11
    v_pk_mul_f32 v[34:35], v[34:35], s[24:25]
    v_cvt_pk_bf16_f32 v11, v34, v35
    v_lshlrev_b32 v34, 16, v11
    v_and_b32 v35, 0xffff0000, v11
    ds_read_b128 v[144:147], v4 offset:12288
    ds_read_b128 v[148:151], v5 offset:12288
    ds_read_b128 v[152:155], v6 offset:12288
    ds_read_b128 v[156:159], v7 offset:12288
    s_waitcnt lgkmcnt(4)
    v_mfma_f32_16x16x32_bf16 v[40:43], v[128:131], v[16:19], v[40:43]
    v_mfma_f32_16x16x32_bf16 v[40:43], v[132:135], v[20:23], v[40:43]
    v_mfma_f32_16x16x32_bf16 v[40:43], v[136:139], v[24:27], v[40:43]
    v_mfma_f32_16x16x32_bf16 v[40:43], v[140:143], v[28:31], v[40:43]
    v_cvt_pk_bf16_f32 v11, v36, v37
    v_lshlrev_b32 v36, 16, v11
    v_and_b32 v37, 0xffff0000, v11
    v_pk_mul_f32 v[36:37], v[36:37], s[24:25]
    v_cvt_pk_bf16_f32 v11, v36, v37
    v_lshlrev_b32 v36, 16, v11
    v_and_b32 v37, 0xffff0000, v11
    v_cvt_pk_bf16_f32 v11, v38, v39
    v_lshlrev_b32 v38, 16, v11
    v_and_b32 v39, 0xffff0000, v11
    v_pk_mul_f32 v[38:39], v[38:39], s[24:25]
    v_cvt_pk_bf16_f32 v11, v38, v39
    v_lshlrev_b32 v38, 16, v11
    v_and_b32 v39, 0xffff0000, v11
    s_waitcnt lgkmcnt(0)
    v_mfma_f32_16x16x32_bf16 v[44:47], v[144:147], v[16:19], v[44:47]
    v_mfma_f32_16x16x32_bf16 v[44:47], v[148:151], v[20:23], v[44:47]
    v_mfma_f32_16x16x32_bf16 v[44:47], v[152:155], v[24:27], v[44:47]
    v_mfma_f32_16x16x32_bf16 v[44:47], v[156:159], v[28:31], v[44:47]
    v_cvt_pk_bf16_f32 v11, v40, v41
    v_lshlrev_b32 v40, 16, v11
    v_and_b32 v41, 0xffff0000, v11
    v_pk_mul_f32 v[40:41], v[40:41], s[24:25]
    v_cvt_pk_bf16_f32 v11, v40, v41
    v_lshlrev_b32 v40, 16, v11
    v_and_b32 v41, 0xffff0000, v11
    v_cvt_pk_bf16_f32 v11, v42, v43
    v_lshlrev_b32 v42, 16, v11
    v_and_b32 v43, 0xffff0000, v11
    v_pk_mul_f32 v[42:43], v[42:43], s[24:25]
    v_cvt_pk_bf16_f32 v11, v42, v43
    v_lshlrev_b32 v42, 16, v11
    v_and_b32 v43, 0xffff0000, v11
    v_cvt_pk_bf16_f32 v11, v44, v45
    v_lshlrev_b32 v44, 16, v11
    v_and_b32 v45, 0xffff0000, v11
    v_pk_mul_f32 v[44:45], v[44:45], s[24:25]
    v_cvt_pk_bf16_f32 v11, v44, v45
    v_lshlrev_b32 v44, 16, v11
    v_and_b32 v45, 0xffff0000, v11
    v_cvt_pk_bf16_f32 v11, v46, v47
    v_lshlrev_b32 v46, 16, v11
    v_and_b32 v47, 0xffff0000, v11
    v_pk_mul_f32 v[46:47], v[46:47], s[24:25]
    v_cvt_pk_bf16_f32 v11, v46, v47
    v_lshlrev_b32 v46, 16, v11
    v_and_b32 v47, 0xffff0000, v11
    v_max3_f32 v12, v32, v33, v34
    v_max3_f32 v12, v12, v35, v36
    v_max3_f32 v12, v12, v37, v38
    v_max3_f32 v12, v12, v39, v40
    v_max3_f32 v12, v12, v41, v42
    v_max_f32 v12, v12, v43
    v_max3_f32 v11, v44, v45, v46
    v_max3_f32 v12, v12, v11, v47
    v_mov_b32 v11, v12
    s_nop 1
    v_permlane16_swap_b32 v12, v11
    v_max_f32 v12, v12, v11
    v_mov_b32 v11, v12
    s_nop 1
    v_permlane32_swap_b32 v12, v11
    v_max_f32 v12, v12, v11
    ds_max_f32 v10, v12
    v_mov_b32 v11, 131120
    v_mov_b32 v15, 1
    s_mov_b64 s[98:99], exec
    s_mov_b64 exec, 1
    ds_add_u32 v11, v15
    s_mov_b64 exec, s[98:99]
    v_mov_b32 v15, v12
L_qkdone:
    s_nop 1
    s_mov_b32 s52, s40
    s_and_b32 s53, s41, 0xffff
    s_mov_b32 s54, 8388608
    s_mov_b32 s55, 0x20000
    s_mov_b32 s60, s16
    s_and_b32 s61, s17, 0xffff
    s_mov_b32 s62, 2048
    s_mov_b32 s63, 0x20000
    s_mov_b32 s84, s34
    s_and_b32 s85, s35, 0xffff
    s_mov_b32 s86, 1024
    s_mov_b32 s87, 0x20000
    s_mov_b32 s88, s36
    s_and_b32 s89, s37, 0xffff
    s_mov_b32 s90, 2048
    s_mov_b32 s91, 0x20000
    v_mov_b32 v128, 0
    v_mov_b32 v129, 0
    v_mov_b32 v130, 0
    v_mov_b32 v131, 0
    v_mov_b32 v132, 0
    v_mov_b32 v133, 0
    v_mov_b32 v134, 0
    v_mov_b32 v135, 0
    v_mov_b32 v136, 0
    v_mov_b32 v137, 0
    v_mov_b32 v138, 0
    v_mov_b32 v139, 0
    v_mov_b32 v140, 0
    v_mov_b32 v141, 0
    v_mov_b32 v142, 0
    v_mov_b32 v143, 0
    v_mov_b32 v144, 0
    v_mov_b32 v145, 0
    v_mov_b32 v146, 0
    v_mov_b32 v147, 0
    v_mov_b32 v148, 0
    v_mov_b32 v149, 0
    v_mov_b32 v150, 0
    v_mov_b32 v151, 0
    v_mov_b32 v152, 0
    v_mov_b32 v153, 0
    v_mov_b32 v154, 0
    v_mov_b32 v155, 0
    v_mov_b32 v156, 0
    v_mov_b32 v157, 0
    v_mov_b32 v158, 0
    v_mov_b32 v159, 0
    v_mov_b32 v60, 0
    v_mov_b32 v61, 0
    v_mov_b32 v62, 0
    v_mov_b32 v63, 0
    s_mov_b32 s9, 0x3fb8aa3b
    v_mul_f32 v12, s9, v15
    v_sub_f32 v12, 0, v12
    v_fma_f32 v32, v32, s9, v12
    v_fma_f32 v33, v33, s9, v12
    v_fma_f32 v34, v34, s9, v12
    v_fma_f32 v35, v35, s9, v12
    v_fma_f32 v36, v36, s9, v12
    v_fma_f32 v37, v37, s9, v12
    v_fma_f32 v38, v38, s9, v12
    v_fma_f32 v39, v39, s9, v12
    v_fma_f32 v40, v40, s9, v12
    v_fma_f32 v41, v41, s9, v12
    v_fma_f32 v42, v42, s9, v12
    v_fma_f32 v43, v43, s9, v12
    v_fma_f32 v44, v44, s9, v12
    v_fma_f32 v45, v45, s9, v12
    v_fma_f32 v46, v46, s9, v12
    v_fma_f32 v47, v47, s9, v12
    v_exp_f32 v32, v32
    v_exp_f32 v33, v33
    v_exp_f32 v34, v34
    v_exp_f32 v35, v35
    v_exp_f32 v36, v36
    v_exp_f32 v37, v37
    v_exp_f32 v38, v38
    v_exp_f32 v39, v39
    v_exp_f32 v40, v40
    v_exp_f32 v41, v41
    v_exp_f32 v42, v42
    v_exp_f32 v43, v43
    v_exp_f32 v44, v44
    v_exp_f32 v45, v45
    v_exp_f32 v46, v46
    v_exp_f32 v47, v47
    v_cvt_pk_bf16_f32 v48, v32, v33
    v_cvt_pk_bf16_f32 v49, v34, v35
    v_cvt_pk_bf16_f32 v50, v36, v37
    v_cvt_pk_bf16_f32 v51, v38, v39
    v_cvt_pk_bf16_f32 v52, v40, v41
    v_cvt_pk_bf16_f32 v53, v42, v43
    v_cvt_pk_bf16_f32 v54, v44, v45
    v_cvt_pk_bf16_f32 v55, v46, v47
    v_mfma_f32_16x16x32_bf16 v[60:63], v[48:51], v[56:59], v[60:63]
    s_nop 0
    v_mfma_f32_16x16x32_bf16 v[60:63], v[52:55], v[56:59], v[60:63]
    v_lshrrev_b32 v4, 2, v2
    v_lshlrev_b32 v4, 2, v4
    v_add_u32 v4, s8, v4
    ds_write_b32 v4, v15 offset:2400
    v_lshlrev_b32 v4, 2, v3
    v_add_u32 v5, s8, v4
    v_add_u32 v6, 131072, v4
    ds_read_b32 v14, v5 offset:2400
    v_lshlrev_b32 v4, 4, v0
    v_add_u32 v4, s8, v4
    s_waitcnt vmcnt(8)
    v_perm_b32 v16, v68, v64, s92
    v_perm_b32 v20, v68, v64, s93
    v_perm_b32 v17, v76, v72, s92
    v_perm_b32 v21, v76, v72, s93
    v_perm_b32 v18, v84, v80, s92
    v_perm_b32 v22, v84, v80, s93
    v_perm_b32 v19, v92, v88, s92
    v_perm_b32 v23, v92, v88, s93
    s_nop 0
    v_mfma_f32_16x16x32_bf16 v[128:131], v[48:51], v[16:19], v[128:131]
    v_mfma_f32_16x16x32_bf16 v[132:135], v[48:51], v[20:23], v[132:135]
    v_perm_b32 v24, v69, v65, s92
    v_perm_b32 v28, v69, v65, s93
    v_perm_b32 v25, v77, v73, s92
    v_perm_b32 v29, v77, v73, s93
    v_perm_b32 v26, v85, v81, s92
    v_perm_b32 v30, v85, v81, s93
    v_perm_b32 v27, v93, v89, s92
    v_perm_b32 v31, v93, v89, s93
    s_nop 0
    v_mfma_f32_16x16x32_bf16 v[136:139], v[48:51], v[24:27], v[136:139]
    v_mfma_f32_16x16x32_bf16 v[140:143], v[48:51], v[28:31], v[140:143]
    v_perm_b32 v16, v70, v66, s92
    v_perm_b32 v20, v70, v66, s93
    v_perm_b32 v17, v78, v74, s92
    v_perm_b32 v21, v78, v74, s93
    v_perm_b32 v18, v86, v82, s92
    v_perm_b32 v22, v86, v82, s93
    v_perm_b32 v19, v94, v90, s92
    v_perm_b32 v23, v94, v90, s93
    s_nop 0
    v_mfma_f32_16x16x32_bf16 v[144:147], v[48:51], v[16:19], v[144:147]
    v_mfma_f32_16x16x32_bf16 v[148:151], v[48:51], v[20:23], v[148:151]
    v_perm_b32 v24, v71, v67, s92
    v_perm_b32 v28, v71, v67, s93
    v_perm_b32 v25, v79, v75, s92
    v_perm_b32 v29, v79, v75, s93
    v_perm_b32 v26, v87, v83, s92
    v_perm_b32 v30, v87, v83, s93
    v_perm_b32 v27, v95, v91, s92
    v_perm_b32 v31, v95, v91, s93
    s_nop 0
    v_mfma_f32_16x16x32_bf16 v[152:155], v[48:51], v[24:27], v[152:155]
    v_mfma_f32_16x16x32_bf16 v[156:159], v[48:51], v[28:31], v[156:159]
    v_mov_b32 v11, 131120
    s_mov_b32 s94, 0
L_mw:
    ds_read_b32 v12, v11
    s_add_u32 s94, s94, 1
    s_waitcnt lgkmcnt(0)
    v_readfirstlane_b32 s9, v12
    s_cmp_gt_u32 s94, 4000000
    s_cbranch_scc1 L_mw_go
    s_cmp_ge_u32 s9, 8
    s_cbranch_scc1 L_mw_go
    s_branch L_mw
L_mw_go:
    ds_read_b32 v12, v6
    s_mov_b32 s9, 0x3fb8aa3b
    s_waitcnt lgkmcnt(0)
    v_sub_f32 v12, v14, v12
    v_mul_f32 v12, s9, v12
    v_exp_f32 v12, v12
    v_lshrrev_b32 v6, 3, v0
    v_and_b32 v7, 7, v0
    s_and_b32 s10, s3, 3
    v_lshlrev_b32 v8, 1, v6
    v_lshrrev_b32 v9, 1, v7
    v_add_u32 v8, v8, v9
    s_lshl_b32 s11, s10, 4
    v_add_u32 v8, s11, v8
    v_lshlrev_b32 v8, 4, v8
    v_and_b32 v9, 1, v7
    v_mul_u32_u24 v9, 1152, v9
    v_add_u32 v8, v8, v9
    s_add_u32 s11, s11, 2304
    v_mov_b32 v9, s11
    v_cmp_lt_u32 s[12:13], 3, v7
    s_nop 1
    v_cndmask_b32 v8, v8, v9, s[12:13]
    v_add_u32 v9, 0x10000, v8
    v_lshlrev_b32 v10, 12, v6
    v_lshlrev_b32 v11, 4, v7
    v_add_u32 v10, v10, v11
    s_lshl_b32 s14, s4, 2
    s_add_u32 s14, s14, s10
    s_lshl_b32 s14, s14, 15
    s_lshl_b32 s15, s6, 4
    s_add_u32 s15, s15, s7
    s_lshl_b32 s15, s15, 7
    s_add_u32 s14, s14, s15
    s_add_u32 s14, s14, 1048576
    s_lshl_b32 s11, s10, 2
    s_add_u32 s11, s11, 131072
    v_mov_b32 v11, s11
    v_cmp_gt_u32 s[10:11], 5, v7
    s_waitcnt vmcnt(0)
    v_perm_b32 v16, v100, v96, s92
    v_perm_b32 v20, v100, v96, s93
    v_perm_b32 v17, v108, v104, s92
    v_perm_b32 v21, v108, v104, s93
    v_perm_b32 v18, v116, v112, s92
    v_perm_b32 v22, v116, v112, s93
    v_perm_b32 v19, v124, v120, s92
    v_perm_b32 v23, v124, v120, s93
    s_nop 0
    v_mfma_f32_16x16x32_bf16 v[128:131], v[52:55], v[16:19], v[128:131]
    v_mfma_f32_16x16x32_bf16 v[132:135], v[52:55], v[20:23], v[132:135]
    v_perm_b32 v24, v101, v97, s92
    v_perm_b32 v28, v101, v97, s93
    v_perm_b32 v25, v109, v105, s92
    v_perm_b32 v29, v109, v105, s93
    v_perm_b32 v26, v117, v113, s92
    v_perm_b32 v30, v117, v113, s93
    v_perm_b32 v27, v125, v121, s92
    v_perm_b32 v31, v125, v121, s93
    s_nop 0
    v_mfma_f32_16x16x32_bf16 v[136:139], v[52:55], v[24:27], v[136:139]
    v_mfma_f32_16x16x32_bf16 v[140:143], v[52:55], v[28:31], v[140:143]
    v_perm_b32 v16, v102, v98, s92
    v_perm_b32 v20, v102, v98, s93
    v_perm_b32 v17, v110, v106, s92
    v_perm_b32 v21, v110, v106, s93
    v_perm_b32 v18, v118, v114, s92
    v_perm_b32 v22, v118, v114, s93
    v_perm_b32 v19, v126, v122, s92
    v_perm_b32 v23, v126, v122, s93
    s_nop 0
    v_mfma_f32_16x16x32_bf16 v[144:147], v[52:55], v[16:19], v[144:147]
    v_mfma_f32_16x16x32_bf16 v[148:151], v[52:55], v[20:23], v[148:151]
    v_perm_b32 v24, v103, v99, s92
    v_perm_b32 v28, v103, v99, s93
    v_perm_b32 v25, v111, v107, s92
    v_perm_b32 v29, v111, v107, s93
    v_perm_b32 v26, v119, v115, s92
    v_perm_b32 v30, v119, v115, s93
    v_perm_b32 v27, v127, v123, s92
    v_perm_b32 v31, v127, v123, s93
    s_nop 0
    v_mfma_f32_16x16x32_bf16 v[152:155], v[52:55], v[24:27], v[152:155]
    v_mfma_f32_16x16x32_bf16 v[156:159], v[52:55], v[28:31], v[156:159]
    v_mul_f32 v32, v12, v128
    v_mul_f32 v33, v12, v132
    v_mul_f32 v34, v12, v136
    v_mul_f32 v35, v12, v140
    v_mul_f32 v36, v12, v144
    v_mul_f32 v37, v12, v148
    s_nop 0
    v_mul_f32 v38, v12, v152
    v_mul_f32 v39, v12, v156
    v_mul_f32 v60, v12, v60
    v_mul_f32 v61, v12, v61
    v_mul_f32 v62, v12, v62
    v_mul_f32 v63, v12, v63
    ds_write_b128 v4, v[32:35]
    ds_write_b128 v4, v[36:39] offset:1152
    v_lshlrev_b32 v5, 4, v3
    v_add_u32 v5, s8, v5
    v_cmp_eq_u32 vcc, 0, v2
    s_nop 0
    s_and_saveexec_b64 s[98:99], vcc
    ds_write_b128 v5, v[60:63] offset:2304
    s_mov_b64 exec, s[98:99]
    s_waitcnt lgkmcnt(0)
    s_barrier
    s_cmp_gt_u32 s3, 3
    s_cbranch_scc1 L_red
    ds_read_b128 v[64:67], v8 offset:0
    ds_read_b128 v[68:71], v8 offset:16384
    ds_read_b128 v[72:75], v8 offset:32768
    ds_read_b128 v[76:79], v8 offset:49152
    ds_read_b128 v[80:83], v9 offset:0
    ds_read_b128 v[84:87], v9 offset:16384
    ds_read_b128 v[88:91], v9 offset:32768
    ds_read_b128 v[92:95], v9 offset:49152
    ds_read_b32 v12, v11
    s_waitcnt lgkmcnt(7)
    v_add_f32 v64, v64, v68
    v_add_f32 v65, v65, v69
    v_add_f32 v66, v66, v70
    v_add_f32 v67, v67, v71
    s_waitcnt lgkmcnt(5)
    v_add_f32 v72, v72, v76
    v_add_f32 v73, v73, v77
    v_add_f32 v74, v74, v78
    v_add_f32 v75, v75, v79
    s_waitcnt lgkmcnt(3)
    v_add_f32 v80, v80, v84
    v_add_f32 v81, v81, v85
    v_add_f32 v82, v82, v86
    v_add_f32 v83, v83, v87
    s_waitcnt lgkmcnt(1)
    v_add_f32 v88, v88, v92
    v_add_f32 v89, v89, v93
    v_add_f32 v90, v90, v94
    v_add_f32 v91, v91, v95
    v_add_f32 v64, v64, v72
    v_add_f32 v80, v80, v88
    v_add_f32 v65, v65, v73
    v_add_f32 v81, v81, v89
    v_add_f32 v66, v66, v74
    v_add_f32 v82, v82, v90
    v_add_f32 v67, v67, v75
    v_add_f32 v83, v83, v91
    v_add_f32 v64, v64, v80
    v_add_f32 v65, v65, v81
    v_add_f32 v66, v66, v82
    v_add_f32 v67, v67, v83
    s_waitcnt lgkmcnt(0)
    v_cndmask_b32 v65, v65, v12, s[12:13]
    v_min_u32 v64, -2, v64
    v_min_u32 v65, -2, v65
    v_min_u32 v66, -2, v66
    v_min_u32 v67, -2, v67
    s_mov_b64 exec, s[10:11]
    buffer_store_dwordx4 v[64:67], v10, s[52:55], s14 offen sc1
    s_mov_b64 exec, -1
L_red:
    s_nop 1
    s_cmp_ge_u32 s2, 64
    s_cbranch_scc1 L_end
    v_and_b32 v4, 3, v0
    v_lshlrev_b32 v4, 3, v4
    s_lshl_b32 s10, s2, 5
    s_and_b32 s9, s10, 1023
    buffer_load_dwordx2 v[8:9], v4, s[60:63], s10 offen
    buffer_load_dwordx2 v[10:11], v4, s[84:87], s9 offen
    s_lshl_b32 s11, s2, 14
    s_add_u32 s11, s11, 2097152
    s_lshl_b32 s12, s3, 11
    s_add_u32 s11, s11, s12
    v_lshlrev_b32 v5, 4, v0
    v_mov_b32 v28, 131100
    v_lshlrev_b32 v6, 1, v4
    s_lshl_b32 s12, s3, 6
    s_add_u32 s12, s12, 137344
    v_add_u32 v6, s12, v6
    v_and_b32 v7, 31, v0
    v_lshlrev_b32 v7, 4, v7
    v_add_u32 v7, 137344, v7
    v_mov_b32 v29, 131112
    v_mov_b32 v30, 1
    s_mov_b32 s94, 0
L_rw:
    ds_read_b32 v12, v28
    s_add_u32 s94, s94, 1
    s_waitcnt lgkmcnt(0)
    v_readfirstlane_b32 s9, v12
    s_cmp_gt_u32 s94, 4000000
    s_cbranch_scc1 L_rw_go
    s_cmp_ge_u32 s9, 1
    s_cbranch_scc1 L_rw_go
    s_sleep 1
    s_branch L_rw
L_rw_go:
    s_sleep 22
    v_lshlrev_b32 v16, 16, v8
    v_and_b32 v17, 0xffff0000, v8
    v_lshlrev_b32 v20, 16, v10
    v_and_b32 v21, 0xffff0000, v10
    v_lshlrev_b32 v18, 16, v9
    v_and_b32 v19, 0xffff0000, v9
    v_lshlrev_b32 v22, 16, v11
    v_and_b32 v23, 0xffff0000, v11
    v_add_f32 v16, v16, v20
    v_add_f32 v17, v17, v21
    v_add_f32 v18, v18, v22
    v_add_f32 v19, v19, v23
    s_mov_b32 s94, 0
    s_mov_b64 s[96:97], -1
    s_mov_b64 s[14:15], -1
L_r_poll:
    s_mov_b64 exec, s[96:97]
    s_cbranch_execz L_r_s1
    buffer_load_dwordx4 v[64:67], v5, s[52:55], s11 offen sc1
L_r_s1:
    s_mov_b64 exec, s[14:15]
    s_cbranch_execz L_r_s2
    buffer_load_dwordx4 v[68:71], v5, s[52:55], s11 offen offset:1024 sc1
L_r_s2:
    s_mov_b64 exec, -1
    s_add_u32 s94, s94, 1
    s_waitcnt vmcnt(0)
    v_max3_u32 v12, v64, v65, v66
    v_max_u32 v12, v12, v67
    v_max3_u32 v13, v68, v69, v70
    v_max_u32 v13, v13, v71
    v_cmp_eq_u32 s[96:97], -1, v12
    v_cmp_eq_u32 s[14:15], -1, v13
    s_cmp_gt_u32 s94, 200000
    s_cbranch_scc1 L_r_go
    s_or_b64 s[12:13], s[96:97], s[14:15]
    s_cbranch_scc0 L_r_go
    s_sleep 4
    s_branch L_r_poll
L_r_go:
    v_add_f32 v64, v64, v68
    v_add_f32 v65, v65, v69
    v_add_f32 v66, v66, v70
    v_add_f32 v67, v67, v71
    v_add_f32 v64, v64, v64 row_ror:8 row_mask:0xf bank_mask:0xf
    v_add_f32 v65, v65, v65 row_ror:8 row_mask:0xf bank_mask:0xf
    v_add_f32 v66, v66, v66 row_ror:8 row_mask:0xf bank_mask:0xf
    v_add_f32 v67, v67, v67 row_ror:8 row_mask:0xf bank_mask:0xf
    v_add_f32 v64, v64, v64 row_ror:4 row_mask:0xf bank_mask:0xf
    v_add_f32 v65, v65, v65 row_ror:4 row_mask:0xf bank_mask:0xf
    v_add_f32 v66, v66, v66 row_ror:4 row_mask:0xf bank_mask:0xf
    v_add_f32 v67, v67, v67 row_ror:4 row_mask:0xf bank_mask:0xf
    v_mov_b32 v72, v64
    s_nop 1
    v_permlane16_swap_b32 v64, v72
    v_add_f32 v64, v64, v72
    v_mov_b32 v73, v65
    s_nop 1
    v_permlane16_swap_b32 v65, v73
    v_add_f32 v65, v65, v73
    v_mov_b32 v74, v66
    s_nop 1
    v_permlane16_swap_b32 v66, v74
    v_add_f32 v66, v66, v74
    v_mov_b32 v75, v67
    s_nop 1
    v_permlane16_swap_b32 v67, v75
    v_add_f32 v67, v67, v75
    v_mov_b32 v72, v64
    s_nop 1
    v_permlane32_swap_b32 v64, v72
    v_add_f32 v64, v64, v72
    v_mov_b32 v73, v65
    s_nop 1
    v_permlane32_swap_b32 v65, v73
    v_add_f32 v65, v65, v73
    v_mov_b32 v74, v66
    s_nop 1
    v_permlane32_swap_b32 v66, v74
    v_add_f32 v66, v66, v74
    v_mov_b32 v75, v67
    s_nop 1
    v_permlane32_swap_b32 v67, v75
    v_add_f32 v67, v67, v75
    s_mov_b64 exec, 15
    ds_write_b128 v6, v[64:67]
    s_mov_b64 exec, 1
    ds_add_rtn_u32 v31, v29, v30
    s_waitcnt lgkmcnt(0)
    v_readfirstlane_b32 s12, v31
    s_mov_b64 exec, -1
    s_cmp_lg_u32 s12, 7
    s_cbranch_scc1 L_end
    ds_read_b128 v[64:67], v7
    s_waitcnt lgkmcnt(0)
    v_add_f32 v64, v64, v64 row_ror:8 row_mask:0xf bank_mask:0xf
    v_add_f32 v65, v65, v65 row_ror:8 row_mask:0xf bank_mask:0xf
    v_add_f32 v66, v66, v66 row_ror:8 row_mask:0xf bank_mask:0xf
    v_add_f32 v67, v67, v67 row_ror:8 row_mask:0xf bank_mask:0xf
    v_add_f32 v64, v64, v64 row_ror:4 row_mask:0xf bank_mask:0xf
    v_add_f32 v65, v65, v65 row_ror:4 row_mask:0xf bank_mask:0xf
    v_add_f32 v66, v66, v66 row_ror:4 row_mask:0xf bank_mask:0xf
    v_add_f32 v67, v67, v67 row_ror:4 row_mask:0xf bank_mask:0xf
    v_mov_b32 v72, v64
    s_nop 1
    v_permlane16_swap_b32 v64, v72
    v_add_f32 v64, v64, v72
    v_mov_b32 v73, v65
    s_nop 1
    v_permlane16_swap_b32 v65, v73
    v_add_f32 v65, v65, v73
    v_mov_b32 v74, v66
    s_nop 1
    v_permlane16_swap_b32 v66, v74
    v_add_f32 v66, v66, v74
    v_mov_b32 v75, v67
    s_nop 1
    v_permlane16_swap_b32 v67, v75
    v_add_f32 v67, v67, v75
    v_add_f32 v64, v64, v16
    v_add_f32 v65, v65, v17
    v_add_f32 v66, v66, v18
    v_add_f32 v67, v67, v19
    v_cvt_pk_bf16_f32 v16, v64, v65
    v_cvt_pk_bf16_f32 v17, v66, v67
    s_mov_b64 exec, 15
    buffer_store_dwordx2 v[16:17], v4, s[88:91], s10 offen
    s_branch L_end
L_helpers:
    s_nop 1
    s_setprio 2
    s_cmp_lg_u32 s3, 0
    s_cbranch_scc1 L_noinit
    v_mov_b32 v4, 0xff800000
    v_cmp_gt_u32 vcc, 4, v0
    s_nop 1
    v_cndmask_b32 v4, 0, v4, vcc
    v_lshlrev_b32 v5, 2, v0
    v_add_u32 v5, 131072, v5
    v_cmp_gt_u32 vcc, 16, v0
    s_nop 0
    s_and_saveexec_b64 s[98:99], vcc
    ds_write_b32 v5, v4
    s_mov_b64 exec, s[98:99]
L_noinit:
    v_lshlrev_b32 v4, 4, v0
    s_waitcnt lgkmcnt(0)
    s_mov_b32 s60, s16
    s_and_b32 s61, s17, 0xffff
    s_mov_b32 s62, 2048
    s_mov_b32 s63, 0x20000
    s_mov_b32 s52, s40
    s_and_b32 s53, s41, 0xffff
    s_mov_b32 s54, 8388608
    s_mov_b32 s55, 0x20000
    s_cmp_eq_u32 s3, 1
    s_cbranch_scc1 L_role1
    s_cmp_eq_u32 s3, 2
    s_cbranch_scc1 L_role2
    s_cmp_eq_u32 s3, 3
    s_cbranch_scc1 L_role3
    s_mov_b32 s64, s22
    s_and_b32 s65, s23, 0xffff
    s_mov_b32 s66, 4194304
    s_mov_b32 s67, 0x20000
    buffer_load_dwordx4 v[16:19], v4, s[60:63], 0 offen
    buffer_load_dwordx4 v[20:23], v4, s[60:63], 0 offen offset:1024
    v_lshrrev_b32 v5, 3, v2
    v_lshlrev_b32 v5, 5, v5
    v_add_u32 v5, v5, v3
    v_lshlrev_b32 v5, 13, v5
    v_and_b32 v6, 7, v2
    v_lshlrev_b32 v6, 4, v6
    v_add_u32 v5, v5, v6
    s_and_b32 s8, s2, 3
    s_lshr_b32 s9, s2, 2
    s_lshl_b32 s10, s8, 20
    s_lshl_b32 s12, s9, 7
    s_add_u32 s10, s10, s12
    s_add_u32 s12, s10, 0
    buffer_load_dwordx4 v[64:67], v5, s[64:67], s12 offen nt
    s_add_u32 s12, s10, 32768
    buffer_load_dwordx4 v[68:71], v5, s[64:67], s12 offen nt
    s_add_u32 s12, s10, 65536
    buffer_load_dwordx4 v[72:75], v5, s[64:67], s12 offen nt
    s_add_u32 s12, s10, 98304
    buffer_load_dwordx4 v[76:79], v5, s[64:67], s12 offen nt
    s_add_u32 s12, s10, 131072
    buffer_load_dwordx4 v[80:83], v5, s[64:67], s12 offen nt
    s_add_u32 s12, s10, 163840
    buffer_load_dwordx4 v[84:87], v5, s[64:67], s12 offen nt
    s_add_u32 s12, s10, 196608
    buffer_load_dwordx4 v[88:91], v5, s[64:67], s12 offen nt
    s_add_u32 s12, s10, 229376
    buffer_load_dwordx4 v[92:95], v5, s[64:67], s12 offen nt
    s_add_u32 s12, s10, 524288
    buffer_load_dwordx4 v[96:99], v5, s[64:67], s12 offen nt
    s_add_u32 s12, s10, 557056
    buffer_load_dwordx4 v[100:103], v5, s[64:67], s12 offen nt
    s_add_u32 s12, s10, 589824
    buffer_load_dwordx4 v[104:107], v5, s[64:67], s12 offen nt
    s_add_u32 s12, s10, 622592
    buffer_load_dwordx4 v[108:111], v5, s[64:67], s12 offen nt
    s_add_u32 s12, s10, 655360
    buffer_load_dwordx4 v[112:115], v5, s[64:67], s12 offen nt
    s_add_u32 s12, s10, 688128
    buffer_load_dwordx4 v[116:119], v5, s[64:67], s12 offen nt
    s_add_u32 s12, s10, 720896
    buffer_load_dwordx4 v[120:123], v5, s[64:67], s12 offen nt
    s_add_u32 s12, s10, 753664
    buffer_load_dwordx4 v[124:127], v5, s[64:67], s12 offen nt
    s_barrier
    s_waitcnt vmcnt(16)
    v_lshlrev_b32 v24, 16, v16
    v_and_b32 v25, 0xffff0000, v16
    v_lshlrev_b32 v26, 16, v17
    v_and_b32 v27, 0xffff0000, v17
    v_lshlrev_b32 v28, 16, v18
    v_and_b32 v29, 0xffff0000, v18
    v_lshlrev_b32 v30, 16, v19
    v_and_b32 v31, 0xffff0000, v19
    v_add_f32 v32, v24, v25
    v_add_f32 v32, v32, v26
    v_add_f32 v32, v32, v27
    v_add_f32 v32, v32, v28
    v_add_f32 v32, v32, v29
    v_add_f32 v32, v32, v30
    v_add_f32 v32, v32, v31
    s_nop 1
    v_add_f32 v32, v32, v32 row_ror:8 row_mask:0xf bank_mask:0xf
    s_nop 1
    v_add_f32 v32, v32, v32 row_ror:4 row_mask:0xf bank_mask:0xf
    s_nop 1
    v_add_f32 v32, v32, v32 row_ror:2 row_mask:0xf bank_mask:0xf
    s_nop 1
    v_add_f32 v32, v32, v32 row_ror:1 row_mask:0xf bank_mask:0xf
    v_mov_b32 v33, v32
    s_nop 1
    v_permlane16_swap_b32 v32, v33
    v_add_f32 v32, v32, v33
    v_mov_b32 v33, v32
    s_nop 1
    v_permlane32_swap_b32 v32, v33
    v_add_f32 v32, v32, v33
    v_mul_f32 v32, 0x3b000000, v32
    v_sub_f32 v34, v24, v32
    v_mul_f32 v35, v34, v34
    v_sub_f32 v34, v25, v32
    v_fmac_f32 v35, v34, v34
    v_sub_f32 v34, v26, v32
    v_fmac_f32 v35, v34, v34
    v_sub_f32 v34, v27, v32
    v_fmac_f32 v35, v34, v34
    v_sub_f32 v34, v28, v32
    v_fmac_f32 v35, v34, v34
    v_sub_f32 v34, v29, v32
    v_fmac_f32 v35, v34, v34
    v_sub_f32 v34, v30, v32
    v_fmac_f32 v35, v34, v34
    v_sub_f32 v34, v31, v32
    v_fmac_f32 v35, v34, v34
    s_nop 1
    v_add_f32 v35, v35, v35 row_ror:8 row_mask:0xf bank_mask:0xf
    s_nop 1
    v_add_f32 v35, v35, v35 row_ror:4 row_mask:0xf bank_mask:0xf
    s_nop 1
    v_add_f32 v35, v35, v35 row_ror:2 row_mask:0xf bank_mask:0xf
    s_nop 1
    v_add_f32 v35, v35, v35 row_ror:1 row_mask:0xf bank_mask:0xf
    v_mov_b32 v33, v35
    s_nop 1
    v_permlane16_swap_b32 v35, v33
    v_add_f32 v35, v35, v33
    v_mov_b32 v33, v35
    s_nop 1
    v_permlane32_swap_b32 v35, v33
    v_add_f32 v35, v35, v33
    v_mul_f32 v35, 0x3b000000, v35
    v_cvt_pk_bf16_f32 v32, v32, v32
    v_lshlrev_b32 v32, 16, v32
    v_cvt_pk_bf16_f32 v35, v35, v35
    v_lshlrev_b32 v35, 16, v35
    v_add_f32 v35, 0x3727c5ac, v35
    v_cvt_pk_bf16_f32 v35, v35, v35
    v_lshlrev_b32 v35, 16, v35
    v_sqrt_f32 v35, v35
    s_nop 0
    v_cvt_pk_bf16_f32 v35, v35, v35
    v_lshlrev_b32 v35, 16, v35
    v_rcp_f32 v35, v35
    v_sub_f32 v24, v24, v32
    v_sub_f32 v25, v25, v32
    v_sub_f32 v26, v26, v32
    v_sub_f32 v27, v27, v32
    v_sub_f32 v28, v28, v32
    v_sub_f32 v29, v29, v32
    v_sub_f32 v30, v30, v32
    v_sub_f32 v31, v31, v32
    v_cvt_pk_bf16_f32 v36, v24, v25
    v_lshlrev_b32 v24, 16, v36
    v_and_b32 v25, 0xffff0000, v36
    v_cvt_pk_bf16_f32 v36, v26, v27
    v_lshlrev_b32 v26, 16, v36
    v_and_b32 v27, 0xffff0000, v36
    v_cvt_pk_bf16_f32 v36, v28, v29
    v_lshlrev_b32 v28, 16, v36
    v_and_b32 v29, 0xffff0000, v36
    v_cvt_pk_bf16_f32 v36, v30, v31
    v_lshlrev_b32 v30, 16, v36
    v_and_b32 v31, 0xffff0000, v36
    v_mul_f32 v24, v24, v35
    v_mul_f32 v25, v25, v35
    v_mul_f32 v26, v26, v35
    v_mul_f32 v27, v27, v35
    v_mul_f32 v28, v28, v35
    v_mul_f32 v29, v29, v35
    v_mul_f32 v30, v30, v35
    v_mul_f32 v31, v31, v35
    v_cvt_pk_bf16_f32 v40, v24, v28
    v_cvt_pk_bf16_f32 v41, v25, v29
    v_cvt_pk_bf16_f32 v42, v26, v30
    v_cvt_pk_bf16_f32 v43, v27, v31
    v_lshlrev_b32 v24, 16, v20
    v_and_b32 v25, 0xffff0000, v20
    v_lshlrev_b32 v26, 16, v21
    v_and_b32 v27, 0xffff0000, v21
    v_lshlrev_b32 v28, 16, v22
    v_and_b32 v29, 0xffff0000, v22
    v_lshlrev_b32 v30, 16, v23
    v_and_b32 v31, 0xffff0000, v23
    v_add_f32 v32, v24, v25
    v_add_f32 v32, v32, v26
    v_add_f32 v32, v32, v27
    v_add_f32 v32, v32, v28
    v_add_f32 v32, v32, v29
    v_add_f32 v32, v32, v30
    v_add_f32 v32, v32, v31
    s_nop 1
    v_add_f32 v32, v32, v32 row_ror:8 row_mask:0xf bank_mask:0xf
    s_nop 1
    v_add_f32 v32, v32, v32 row_ror:4 row_mask:0xf bank_mask:0xf
    s_nop 1
    v_add_f32 v32, v32, v32 row_ror:2 row_mask:0xf bank_mask:0xf
    s_nop 1
    v_add_f32 v32, v32, v32 row_ror:1 row_mask:0xf bank_mask:0xf
    v_mov_b32 v33, v32
    s_nop 1
    v_permlane16_swap_b32 v32, v33
    v_add_f32 v32, v32, v33
    v_mov_b32 v33, v32
    s_nop 1
    v_permlane32_swap_b32 v32, v33
    v_add_f32 v32, v32, v33
    v_mul_f32 v32, 0x3b000000, v32
    v_sub_f32 v34, v24, v32
    v_mul_f32 v35, v34, v34
    v_sub_f32 v34, v25, v32
    v_fmac_f32 v35, v34, v34
    v_sub_f32 v34, v26, v32
    v_fmac_f32 v35, v34, v34
    v_sub_f32 v34, v27, v32
    v_fmac_f32 v35, v34, v34
    v_sub_f32 v34, v28, v32
    v_fmac_f32 v35, v34, v34
    v_sub_f32 v34, v29, v32
    v_fmac_f32 v35, v34, v34
    v_sub_f32 v34, v30, v32
    v_fmac_f32 v35, v34, v34
    v_sub_f32 v34, v31, v32
    v_fmac_f32 v35, v34, v34
    s_nop 1
    v_add_f32 v35, v35, v35 row_ror:8 row_mask:0xf bank_mask:0xf
    s_nop 1
    v_add_f32 v35, v35, v35 row_ror:4 row_mask:0xf bank_mask:0xf
    s_nop 1
    v_add_f32 v35, v35, v35 row_ror:2 row_mask:0xf bank_mask:0xf
    s_nop 1
    v_add_f32 v35, v35, v35 row_ror:1 row_mask:0xf bank_mask:0xf
    v_mov_b32 v33, v35
    s_nop 1
    v_permlane16_swap_b32 v35, v33
    v_add_f32 v35, v35, v33
    v_mov_b32 v33, v35
    s_nop 1
    v_permlane32_swap_b32 v35, v33
    v_add_f32 v35, v35, v33
    v_mul_f32 v35, 0x3b000000, v35
    v_cvt_pk_bf16_f32 v32, v32, v32
    v_lshlrev_b32 v32, 16, v32
    v_cvt_pk_bf16_f32 v35, v35, v35
    v_lshlrev_b32 v35, 16, v35
    v_add_f32 v35, 0x3727c5ac, v35
    v_cvt_pk_bf16_f32 v35, v35, v35
    v_lshlrev_b32 v35, 16, v35
    v_sqrt_f32 v35, v35
    s_nop 0
    v_cvt_pk_bf16_f32 v35, v35, v35
    v_lshlrev_b32 v35, 16, v35
    v_rcp_f32 v35, v35
    v_sub_f32 v24, v24, v32
    v_sub_f32 v25, v25, v32
    v_sub_f32 v26, v26, v32
    v_sub_f32 v27, v27, v32
    v_sub_f32 v28, v28, v32
    v_sub_f32 v29, v29, v32
    v_sub_f32 v30, v30, v32
    v_sub_f32 v31, v31, v32
    v_cvt_pk_bf16_f32 v36, v24, v25
    v_lshlrev_b32 v24, 16, v36
    v_and_b32 v25, 0xffff0000, v36
    v_cvt_pk_bf16_f32 v36, v26, v27
    v_lshlrev_b32 v26, 16, v36
    v_and_b32 v27, 0xffff0000, v36
    v_cvt_pk_bf16_f32 v36, v28, v29
    v_lshlrev_b32 v28, 16, v36
    v_and_b32 v29, 0xffff0000, v36
    v_cvt_pk_bf16_f32 v36, v30, v31
    v_lshlrev_b32 v30, 16, v36
    v_and_b32 v31, 0xffff0000, v36
    v_mul_f32 v24, v24, v35
    v_mul_f32 v25, v25, v35
    v_mul_f32 v26, v26, v35
    v_mul_f32 v27, v27, v35
    v_mul_f32 v28, v28, v35
    v_mul_f32 v29, v29, v35
    v_mul_f32 v30, v30, v35
    v_mul_f32 v31, v31, v35
    v_cvt_pk_bf16_f32 v44, v24, v28
    v_cvt_pk_bf16_f32 v45, v25, v29
    v_cvt_pk_bf16_f32 v46, v26, v30
    v_cvt_pk_bf16_f32 v47, v27, v31
    v_lshrrev_b32 v6, 2, v0
    v_lshlrev_b32 v6, 6, v6
    v_and_b32 v7, 3, v0
    v_lshlrev_b32 v7, 2, v7
    v_add_u32 v6, v6, v7
    v_add_u32 v6, 133120, v6
    ds_write_b32 v6, v40 offset:0
    ds_write_b32 v6, v44 offset:1024
    ds_write_b32 v6, v41 offset:16
    ds_write_b32 v6, v45 offset:1040
    ds_write_b32 v6, v42 offset:32
    ds_write_b32 v6, v46 offset:1056
    ds_write_b32 v6, v43 offset:48
    ds_write_b32 v6, v47 offset:1072
    v_and_b32 v7, 1, v0
    v_lshlrev_b32 v7, 10, v7
    v_bfe_u32 v6, v0, 1, 1
    v_lshlrev_b32 v6, 6, v6
    v_add_u32 v7, v7, v6
    v_lshlrev_b32 v6, 4, v3
    v_add_u32 v7, v7, v6
    s_lshl_b32 s12, s8, 8
    s_add_u32 s12, s12, 133120
    v_add_u32 v7, s12, v7
    s_waitcnt lgkmcnt(0)
    ds_read_b128 v[48:51], v7
    ds_read_b128 v[52:55], v7 offset:128
    v_mov_b32 v128, 0
    v_mov_b32 v129, 0
    v_mov_b32 v130, 0
    v_mov_b32 v131, 0
    v_mov_b32 v132, 0
    v_mov_b32 v133, 0
    v_mov_b32 v134, 0
    v_mov_b32 v135, 0
    v_mov_b32 v136, 0
    v_mov_b32 v137, 0
    v_mov_b32 v138, 0
    v_mov_b32 v139, 0
    v_mov_b32 v140, 0
    v_mov_b32 v141, 0
    v_mov_b32 v142, 0
    v_mov_b32 v143, 0
    v_mov_b32 v144, 0
    v_mov_b32 v145, 0
    v_mov_b32 v146, 0
    v_mov_b32 v147, 0
    v_mov_b32 v148, 0
    v_mov_b32 v149, 0
    v_mov_b32 v150, 0
    v_mov_b32 v151, 0
    v_mov_b32 v152, 0
    v_mov_b32 v153, 0
    v_mov_b32 v154, 0
    v_mov_b32 v155, 0
    v_mov_b32 v156, 0
    v_mov_b32 v157, 0
    v_mov_b32 v158, 0
    v_mov_b32 v159, 0
    s_waitcnt vmcnt(0) lgkmcnt(0)
    v_perm_b32 v160, v68, v64, s92
    v_perm_b32 v164, v68, v64, s93
    v_perm_b32 v161, v76, v72, s92
    v_perm_b32 v165, v76, v72, s93
    v_perm_b32 v162, v84, v80, s92
    v_perm_b32 v166, v84, v80, s93
    v_perm_b32 v163, v92, v88, s92
    v_perm_b32 v167, v92, v88, s93
    s_nop 0
    v_mfma_f32_16x16x32_bf16 v[128:131], v[48:51], v[160:163], v[128:131]
    v_mfma_f32_16x16x32_bf16 v[132:135], v[48:51], v[164:167], v[132:135]
    v_perm_b32 v8, v69, v65, s92
    v_perm_b32 v12, v69, v65, s93
    v_perm_b32 v9, v77, v73, s92
    v_perm_b32 v13, v77, v73, s93
    v_perm_b32 v10, v85, v81, s92
    v_perm_b32 v14, v85, v81, s93
    v_perm_b32 v11, v93, v89, s92
    v_perm_b32 v15, v93, v89, s93
    s_nop 0
    v_mfma_f32_16x16x32_bf16 v[136:139], v[48:51], v[8:11], v[136:139]
    v_mfma_f32_16x16x32_bf16 v[140:143], v[48:51], v[12:15], v[140:143]
    v_perm_b32 v160, v70, v66, s92
    v_perm_b32 v164, v70, v66, s93
    v_perm_b32 v161, v78, v74, s92
    v_perm_b32 v165, v78, v74, s93
    v_perm_b32 v162, v86, v82, s92
    v_perm_b32 v166, v86, v82, s93
    v_perm_b32 v163, v94, v90, s92
    v_perm_b32 v167, v94, v90, s93
    s_nop 0
    v_mfma_f32_16x16x32_bf16 v[144:147], v[48:51], v[160:163], v[144:147]
    v_mfma_f32_16x16x32_bf16 v[148:151], v[48:51], v[164:167], v[148:151]
    v_perm_b32 v8, v71, v67, s92
    v_perm_b32 v12, v71, v67, s93
    v_perm_b32 v9, v79, v75, s92
    v_perm_b32 v13, v79, v75, s93
    v_perm_b32 v10, v87, v83, s92
    v_perm_b32 v14, v87, v83, s93
    v_perm_b32 v11, v95, v91, s92
    v_perm_b32 v15, v95, v91, s93
    s_nop 0
    v_mfma_f32_16x16x32_bf16 v[152:155], v[48:51], v[8:11], v[152:155]
    v_mfma_f32_16x16x32_bf16 v[156:159], v[48:51], v[12:15], v[156:159]
    v_perm_b32 v160, v100, v96, s92
    v_perm_b32 v164, v100, v96, s93
    v_perm_b32 v161, v108, v104, s92
    v_perm_b32 v165, v108, v104, s93
    v_perm_b32 v162, v116, v112, s92
    v_perm_b32 v166, v116, v112, s93
    v_perm_b32 v163, v124, v120, s92
    v_perm_b32 v167, v124, v120, s93
    s_nop 0
    v_mfma_f32_16x16x32_bf16 v[128:131], v[52:55], v[160:163], v[128:131]
    v_mfma_f32_16x16x32_bf16 v[132:135], v[52:55], v[164:167], v[132:135]
    v_perm_b32 v8, v101, v97, s92
    v_perm_b32 v12, v101, v97, s93
    v_perm_b32 v9, v109, v105, s92
    v_perm_b32 v13, v109, v105, s93
    v_perm_b32 v10, v117, v113, s92
    v_perm_b32 v14, v117, v113, s93
    v_perm_b32 v11, v125, v121, s92
    v_perm_b32 v15, v125, v121, s93
    s_nop 0
    v_mfma_f32_16x16x32_bf16 v[136:139], v[52:55], v[8:11], v[136:139]
    v_mfma_f32_16x16x32_bf16 v[140:143], v[52:55], v[12:15], v[140:143]
    v_perm_b32 v160, v102, v98, s92
    v_perm_b32 v164, v102, v98, s93
    v_perm_b32 v161, v110, v106, s92
    v_perm_b32 v165, v110, v106, s93
    v_perm_b32 v162, v118, v114, s92
    v_perm_b32 v166, v118, v114, s93
    v_perm_b32 v163, v126, v122, s92
    v_perm_b32 v167, v126, v122, s93
    s_nop 0
    v_mfma_f32_16x16x32_bf16 v[144:147], v[52:55], v[160:163], v[144:147]
    v_mfma_f32_16x16x32_bf16 v[148:151], v[52:55], v[164:167], v[148:151]
    v_perm_b32 v8, v103, v99, s92
    v_perm_b32 v12, v103, v99, s93
    v_perm_b32 v9, v111, v107, s92
    v_perm_b32 v13, v111, v107, s93
    v_perm_b32 v10, v119, v115, s92
    v_perm_b32 v14, v119, v115, s93
    v_perm_b32 v11, v127, v123, s92
    v_perm_b32 v15, v127, v123, s93
    s_nop 0
    v_mfma_f32_16x16x32_bf16 v[152:155], v[52:55], v[8:11], v[152:155]
    v_mfma_f32_16x16x32_bf16 v[156:159], v[52:55], v[12:15], v[156:159]
    s_lshl_b32 s13, s2, 9
    v_cmp_lt_u32 s[8:9], 7, v2
    s_nop 1
    v_cndmask_b32 v24, v128, v130, s[8:9]
    v_cndmask_b32 v32, v129, v131, s[8:9]
    v_cndmask_b32 v25, v132, v134, s[8:9]
    v_cndmask_b32 v33, v133, v135, s[8:9]
    v_cndmask_b32 v26, v136, v138, s[8:9]
    v_cndmask_b32 v34, v137, v139, s[8:9]
    v_cndmask_b32 v27, v140, v142, s[8:9]
    v_cndmask_b32 v35, v141, v143, s[8:9]
    v_cndmask_b32 v28, v144, v146, s[8:9]
    v_cndmask_b32 v36, v145, v147, s[8:9]
    v_cndmask_b32 v29, v148, v150, s[8:9]
    v_cndmask_b32 v37, v149, v151, s[8:9]
    v_cndmask_b32 v30, v152, v154, s[8:9]
    v_cndmask_b32 v38, v153, v155, s[8:9]
    v_cndmask_b32 v31, v156, v158, s[8:9]
    v_cndmask_b32 v39, v157, v159, s[8:9]
    v_add_f32 v24, v24, v24 row_ror:8 row_mask:0xf bank_mask:0xf
    v_add_f32 v25, v25, v25 row_ror:8 row_mask:0xf bank_mask:0xf
    v_add_f32 v26, v26, v26 row_ror:8 row_mask:0xf bank_mask:0xf
    v_add_f32 v27, v27, v27 row_ror:8 row_mask:0xf bank_mask:0xf
    v_add_f32 v28, v28, v28 row_ror:8 row_mask:0xf bank_mask:0xf
    v_add_f32 v29, v29, v29 row_ror:8 row_mask:0xf bank_mask:0xf
    v_add_f32 v30, v30, v30 row_ror:8 row_mask:0xf bank_mask:0xf
    v_add_f32 v31, v31, v31 row_ror:8 row_mask:0xf bank_mask:0xf
    v_add_f32 v32, v32, v32 row_ror:8 row_mask:0xf bank_mask:0xf
    v_add_f32 v33, v33, v33 row_ror:8 row_mask:0xf bank_mask:0xf
    v_add_f32 v34, v34, v34 row_ror:8 row_mask:0xf bank_mask:0xf
    v_add_f32 v35, v35, v35 row_ror:8 row_mask:0xf bank_mask:0xf
    v_add_f32 v36, v36, v36 row_ror:8 row_mask:0xf bank_mask:0xf
    v_add_f32 v37, v37, v37 row_ror:8 row_mask:0xf bank_mask:0xf
    v_add_f32 v38, v38, v38 row_ror:8 row_mask:0xf bank_mask:0xf
    v_add_f32 v39, v39, v39 row_ror:8 row_mask:0xf bank_mask:0xf
    v_and_b32 v6, 1, v3
    v_cmp_eq_u32 s[8:9], 1, v6
    v_cmp_lt_u32 s[10:11], 1, v3
    s_nop 0
    v_cndmask_b32 v16, v24, v28, s[8:9]
    v_cndmask_b32 v20, v32, v36, s[8:9]
    v_cndmask_b32 v17, v25, v29, s[8:9]
    v_cndmask_b32 v21, v33, v37, s[8:9]
    v_cndmask_b32 v18, v26, v30, s[8:9]
    v_cndmask_b32 v22, v34, v38, s[8:9]
    v_cndmask_b32 v19, v27, v31, s[8:9]
    v_cndmask_b32 v23, v35, v39, s[8:9]
    v_cndmask_b32 v16, v16, v20, s[10:11]
    v_cndmask_b32 v17, v17, v21, s[10:11]
    v_cndmask_b32 v18, v18, v22, s[10:11]
    v_cndmask_b32 v19, v19, v23, s[10:11]
    v_lshrrev_b32 v7, 1, v3
    v_lshlrev_b32 v7, 8, v7
    v_lshlrev_b32 v6, 4, v6
    v_add_u32 v7, v7, v6
    v_and_b32 v6, 7, v2
    v_lshlrev_b32 v6, 5, v6
    v_add_u32 v7, v7, v6
    v_cmp_gt_u32 vcc, 8, v2
    s_nop 0
    s_and_saveexec_b64 s[98:99], vcc
    buffer_store_dwordx4 v[16:19], v7, s[52:55], s13 offen sc1
    s_mov_b64 exec, s[98:99]
    s_waitcnt vmcnt(0)
    v_mov_b32 v11, 131104
    s_mov_b32 s94, 0
L_r0_wn:
    ds_read_b32 v12, v11
    s_add_u32 s94, s94, 1
    s_waitcnt lgkmcnt(0)
    v_readfirstlane_b32 s9, v12
    s_cmp_gt_u32 s94, 4000000
    s_cbranch_scc1 L_r0_wn_go
    s_cmp_ge_u32 s9, 1
    s_cbranch_scc1 L_r0_wn_go
    s_sleep 1
    s_branch L_r0_wn
L_r0_wn_go:
    ds_read_b64 v[8:9], v11
    v_mov_b32 v10, 0
    s_lshl_b32 s12, s2, 3
    s_add_u32 s12, s12, 528384
    s_waitcnt lgkmcnt(0)
    s_mov_b64 s[98:99], exec
    s_mov_b64 exec, 1
    buffer_store_dwordx2 v[8:9], v10, s[52:55], s12 offen sc1
    s_mov_b64 exec, s[98:99]
    s_branch L_hwait
L_role1:
    s_nop 1
    s_mov_b32 s72, s28
    s_and_b32 s73, s29, 0xffff
    s_mov_b32 s74, 1835008
    s_mov_b32 s75, 0x20000
    s_cmp_ge_u32 s2, 224
    s_cbranch_scc1 L_r1_clr
    buffer_load_dwordx4 v[16:19], v4, s[60:63], 0 offen
    buffer_load_dwordx4 v[20:23], v4, s[60:63], 0 offen offset:1024
    v_lshrrev_b32 v5, 3, v2
    v_lshlrev_b32 v5, 5, v5
    v_add_u32 v5, v5, v3
    v_mul_u32_u24 v5, 3584, v5
    v_and_b32 v6, 7, v2
    v_lshlrev_b32 v6, 4, v6
    v_add_u32 v5, v5, v6
    s_and_b32 s8, s2, 7
    s_lshr_b32 s9, s2, 3
    s_mul_i32 s10, s8, 229376
    s_lshl_b32 s12, s9, 7
    s_add_u32 s10, s10, s12
    s_add_u32 s12, s10, 0
    buffer_load_dwordx4 v[64:67], v5, s[72:75], s12 offen nt
    s_add_u32 s12, s10, 14336
    buffer_load_dwordx4 v[68:71], v5, s[72:75], s12 offen nt
    s_add_u32 s12, s10, 28672
    buffer_load_dwordx4 v[72:75], v5, s[72:75], s12 offen nt
    s_add_u32 s12, s10, 43008
    buffer_load_dwordx4 v[76:79], v5, s[72:75], s12 offen nt
    s_add_u32 s12, s10, 57344
    buffer_load_dwordx4 v[80:83], v5, s[72:75], s12 offen nt
    s_add_u32 s12, s10, 71680
    buffer_load_dwordx4 v[84:87], v5, s[72:75], s12 offen nt
    s_add_u32 s12, s10, 86016
    buffer_load_dwordx4 v[88:91], v5, s[72:75], s12 offen nt
    s_add_u32 s12, s10, 100352
    buffer_load_dwordx4 v[92:95], v5, s[72:75], s12 offen nt
L_r1_clr:
    v_mov_b32 v8, -1
    v_mov_b32 v9, -1
    v_mov_b32 v10, -1
    v_mov_b32 v11, -1
    s_lshl_b32 s12, s2, 12
    s_add_u32 s13, s12, 1048576
    s_add_u32 s12, s12, 2097152
    buffer_store_dwordx4 v[8:11], v4, s[52:55], s13 offen offset:0 sc1
    buffer_store_dwordx4 v[8:11], v4, s[52:55], s13 offen offset:1024 sc1
    buffer_store_dwordx4 v[8:11], v4, s[52:55], s13 offen offset:2048 sc1
    buffer_store_dwordx4 v[8:11], v4, s[52:55], s13 offen offset:3072 sc1
    buffer_store_dwordx4 v[8:11], v4, s[52:55], s12 offen offset:0 sc1
    buffer_store_dwordx4 v[8:11], v4, s[52:55], s12 offen offset:1024 sc1
    buffer_store_dwordx4 v[8:11], v4, s[52:55], s12 offen offset:2048 sc1
    buffer_store_dwordx4 v[8:11], v4, s[52:55], s12 offen offset:3072 sc1
    s_barrier
    s_cmp_ge_u32 s2, 224
    s_cbranch_scc1 L_r1_done
    s_waitcnt vmcnt(16)
    v_lshlrev_b32 v24, 16, v16
    v_and_b32 v25, 0xffff0000, v16
    v_lshlrev_b32 v26, 16, v17
    v_and_b32 v27, 0xffff0000, v17
    v_lshlrev_b32 v28, 16, v18
    v_and_b32 v29, 0xffff0000, v18
    v_lshlrev_b32 v30, 16, v19
    v_and_b32 v31, 0xffff0000, v19
    v_add_f32 v32, v24, v25
    v_add_f32 v32, v32, v26
    v_add_f32 v32, v32, v27
    v_add_f32 v32, v32, v28
    v_add_f32 v32, v32, v29
    v_add_f32 v32, v32, v30
    v_add_f32 v32, v32, v31
    s_nop 1
    v_add_f32 v32, v32, v32 row_ror:8 row_mask:0xf bank_mask:0xf
    s_nop 1
    v_add_f32 v32, v32, v32 row_ror:4 row_mask:0xf bank_mask:0xf
    s_nop 1
    v_add_f32 v32, v32, v32 row_ror:2 row_mask:0xf bank_mask:0xf
    s_nop 1
    v_add_f32 v32, v32, v32 row_ror:1 row_mask:0xf bank_mask:0xf
    v_mov_b32 v33, v32
    s_nop 1
    v_permlane16_swap_b32 v32, v33
    v_add_f32 v32, v32, v33
    v_mov_b32 v33, v32
    s_nop 1
    v_permlane32_swap_b32 v32, v33
    v_add_f32 v32, v32, v33
    v_mul_f32 v32, 0x3b000000, v32
    v_sub_f32 v34, v24, v32
    v_mul_f32 v35, v34, v34
    v_sub_f32 v34, v25, v32
    v_fmac_f32 v35, v34, v34
    v_sub_f32 v34, v26, v32
    v_fmac_f32 v35, v34, v34
    v_sub_f32 v34, v27, v32
    v_fmac_f32 v35, v34, v34
    v_sub_f32 v34, v28, v32
    v_fmac_f32 v35, v34, v34
    v_sub_f32 v34, v29, v32
    v_fmac_f32 v35, v34, v34
    v_sub_f32 v34, v30, v32
    v_fmac_f32 v35, v34, v34
    v_sub_f32 v34, v31, v32
    v_fmac_f32 v35, v34, v34
    s_nop 1
    v_add_f32 v35, v35, v35 row_ror:8 row_mask:0xf bank_mask:0xf
    s_nop 1
    v_add_f32 v35, v35, v35 row_ror:4 row_mask:0xf bank_mask:0xf
    s_nop 1
    v_add_f32 v35, v35, v35 row_ror:2 row_mask:0xf bank_mask:0xf
    s_nop 1
    v_add_f32 v35, v35, v35 row_ror:1 row_mask:0xf bank_mask:0xf
    v_mov_b32 v33, v35
    s_nop 1
    v_permlane16_swap_b32 v35, v33
    v_add_f32 v35, v35, v33
    v_mov_b32 v33, v35
    s_nop 1
    v_permlane32_swap_b32 v35, v33
    v_add_f32 v35, v35, v33
    v_mul_f32 v35, 0x3b000000, v35
    v_cvt_pk_bf16_f32 v32, v32, v32
    v_lshlrev_b32 v32, 16, v32
    v_cvt_pk_bf16_f32 v35, v35, v35
    v_lshlrev_b32 v35, 16, v35
    v_add_f32 v35, 0x3727c5ac, v35
    v_cvt_pk_bf16_f32 v35, v35, v35
    v_lshlrev_b32 v35, 16, v35
    v_sqrt_f32 v35, v35
    s_nop 0
    v_cvt_pk_bf16_f32 v35, v35, v35
    v_lshlrev_b32 v35, 16, v35
    v_rcp_f32 v35, v35
    v_sub_f32 v24, v24, v32
    v_sub_f32 v25, v25, v32
    v_sub_f32 v26, v26, v32
    v_sub_f32 v27, v27, v32
    v_sub_f32 v28, v28, v32
    v_sub_f32 v29, v29, v32
    v_sub_f32 v30, v30, v32
    v_sub_f32 v31, v31, v32
    v_cvt_pk_bf16_f32 v36, v24, v25
    v_lshlrev_b32 v24, 16, v36
    v_and_b32 v25, 0xffff0000, v36
    v_cvt_pk_bf16_f32 v36, v26, v27
    v_lshlrev_b32 v26, 16, v36
    v_and_b32 v27, 0xffff0000, v36
    v_cvt_pk_bf16_f32 v36, v28, v29
    v_lshlrev_b32 v28, 16, v36
    v_and_b32 v29, 0xffff0000, v36
    v_cvt_pk_bf16_f32 v36, v30, v31
    v_lshlrev_b32 v30, 16, v36
    v_and_b32 v31, 0xffff0000, v36
    v_mul_f32 v24, v24, v35
    v_mul_f32 v25, v25, v35
    v_mul_f32 v26, v26, v35
    v_mul_f32 v27, v27, v35
    v_mul_f32 v28, v28, v35
    v_mul_f32 v29, v29, v35
    v_mul_f32 v30, v30, v35
    v_mul_f32 v31, v31, v35
    v_cvt_pk_bf16_f32 v40, v24, v28
    v_cvt_pk_bf16_f32 v41, v25, v29
    v_cvt_pk_bf16_f32 v42, v26, v30
    v_cvt_pk_bf16_f32 v43, v27, v31
    v_lshlrev_b32 v24, 16, v20
    v_and_b32 v25, 0xffff0000, v20
    v_lshlrev_b32 v26, 16, v21
    v_and_b32 v27, 0xffff0000, v21
    v_lshlrev_b32 v28, 16, v22
    v_and_b32 v29, 0xffff0000, v22
    v_lshlrev_b32 v30, 16, v23
    v_and_b32 v31, 0xffff0000, v23
    v_add_f32 v32, v24, v25
    v_add_f32 v32, v32, v26
    v_add_f32 v32, v32, v27
    v_add_f32 v32, v32, v28
    v_add_f32 v32, v32, v29
    v_add_f32 v32, v32, v30
    v_add_f32 v32, v32, v31
    s_nop 1
    v_add_f32 v32, v32, v32 row_ror:8 row_mask:0xf bank_mask:0xf
    s_nop 1
    v_add_f32 v32, v32, v32 row_ror:4 row_mask:0xf bank_mask:0xf
    s_nop 1
    v_add_f32 v32, v32, v32 row_ror:2 row_mask:0xf bank_mask:0xf
    s_nop 1
    v_add_f32 v32, v32, v32 row_ror:1 row_mask:0xf bank_mask:0xf
    v_mov_b32 v33, v32
    s_nop 1
    v_permlane16_swap_b32 v32, v33
    v_add_f32 v32, v32, v33
    v_mov_b32 v33, v32
    s_nop 1
    v_permlane32_swap_b32 v32, v33
    v_add_f32 v32, v32, v33
    v_mul_f32 v32, 0x3b000000, v32
    v_sub_f32 v34, v24, v32
    v_mul_f32 v35, v34, v34
    v_sub_f32 v34, v25, v32
    v_fmac_f32 v35, v34, v34
    v_sub_f32 v34, v26, v32
    v_fmac_f32 v35, v34, v34
    v_sub_f32 v34, v27, v32
    v_fmac_f32 v35, v34, v34
    v_sub_f32 v34, v28, v32
    v_fmac_f32 v35, v34, v34
    v_sub_f32 v34, v29, v32
    v_fmac_f32 v35, v34, v34
    v_sub_f32 v34, v30, v32
    v_fmac_f32 v35, v34, v34
    v_sub_f32 v34, v31, v32
    v_fmac_f32 v35, v34, v34
    s_nop 1
    v_add_f32 v35, v35, v35 row_ror:8 row_mask:0xf bank_mask:0xf
    s_nop 1
    v_add_f32 v35, v35, v35 row_ror:4 row_mask:0xf bank_mask:0xf
    s_nop 1
    v_add_f32 v35, v35, v35 row_ror:2 row_mask:0xf bank_mask:0xf
    s_nop 1
    v_add_f32 v35, v35, v35 row_ror:1 row_mask:0xf bank_mask:0xf
    v_mov_b32 v33, v35
    s_nop 1
    v_permlane16_swap_b32 v35, v33
    v_add_f32 v35, v35, v33
    v_mov_b32 v33, v35
    s_nop 1
    v_permlane32_swap_b32 v35, v33
    v_add_f32 v35, v35, v33
    v_mul_f32 v35, 0x3b000000, v35
    v_cvt_pk_bf16_f32 v32, v32, v32
    v_lshlrev_b32 v32, 16, v32
    v_cvt_pk_bf16_f32 v35, v35, v35
    v_lshlrev_b32 v35, 16, v35
    v_add_f32 v35, 0x3727c5ac, v35
    v_cvt_pk_bf16_f32 v35, v35, v35
    v_lshlrev_b32 v35, 16, v35
    v_sqrt_f32 v35, v35
    s_nop 0
    v_cvt_pk_bf16_f32 v35, v35, v35
    v_lshlrev_b32 v35, 16, v35
    v_rcp_f32 v35, v35
    v_sub_f32 v24, v24, v32
    v_sub_f32 v25, v25, v32
    v_sub_f32 v26, v26, v32
    v_sub_f32 v27, v27, v32
    v_sub_f32 v28, v28, v32
    v_sub_f32 v29, v29, v32
    v_sub_f32 v30, v30, v32
    v_sub_f32 v31, v31, v32
    v_cvt_pk_bf16_f32 v36, v24, v25
    v_lshlrev_b32 v24, 16, v36
    v_and_b32 v25, 0xffff0000, v36
    v_cvt_pk_bf16_f32 v36, v26, v27
    v_lshlrev_b32 v26, 16, v36
    v_and_b32 v27, 0xffff0000, v36
    v_cvt_pk_bf16_f32 v36, v28, v29
    v_lshlrev_b32 v28, 16, v36
    v_and_b32 v29, 0xffff0000, v36
    v_cvt_pk_bf16_f32 v36, v30, v31
    v_lshlrev_b32 v30, 16, v36
    v_and_b32 v31, 0xffff0000, v36
    v_mul_f32 v24, v24, v35
    v_mul_f32 v25, v25, v35
    v_mul_f32 v26, v26, v35
    v_mul_f32 v27, v27, v35
    v_mul_f32 v28, v28, v35
    v_mul_f32 v29, v29, v35
    v_mul_f32 v30, v30, v35
    v_mul_f32 v31, v31, v35
    v_cvt_pk_bf16_f32 v44, v24, v28
    v_cvt_pk_bf16_f32 v45, v25, v29
    v_cvt_pk_bf16_f32 v46, v26, v30
    v_cvt_pk_bf16_f32 v47, v27, v31
    v_lshrrev_b32 v6, 2, v0
    v_lshlrev_b32 v6, 6, v6
    v_and_b32 v7, 3, v0
    v_lshlrev_b32 v7, 2, v7
    v_add_u32 v6, v6, v7
    v_add_u32 v6, 135168, v6
    ds_write_b32 v6, v40 offset:0
    ds_write_b32 v6, v44 offset:1024
    ds_write_b32 v6, v41 offset:16
    ds_write_b32 v6, v45 offset:1040
    ds_write_b32 v6, v42 offset:32
    ds_write_b32 v6, v46 offset:1056
    ds_write_b32 v6, v43 offset:48
    ds_write_b32 v6, v47 offset:1072
    v_and_b32 v7, 1, v0
    v_lshlrev_b32 v7, 10, v7
    v_bfe_u32 v6, v0, 1, 1
    v_lshlrev_b32 v6, 6, v6
    v_add_u32 v7, v7, v6
    v_lshlrev_b32 v6, 4, v3
    v_add_u32 v7, v7, v6
    s_lshl_b32 s12, s8, 7
    s_add_u32 s12, s12, 135168
    v_add_u32 v7, s12, v7
    s_waitcnt lgkmcnt(0)
    ds_read_b128 v[48:51], v7
    v_mov_b32 v128, 0
    v_mov_b32 v129, 0
    v_mov_b32 v130, 0
    v_mov_b32 v131, 0
    v_mov_b32 v132, 0
    v_mov_b32 v133, 0
    v_mov_b32 v134, 0
    v_mov_b32 v135, 0
    v_mov_b32 v136, 0
    v_mov_b32 v137, 0
    v_mov_b32 v138, 0
    v_mov_b32 v139, 0
    v_mov_b32 v140, 0
    v_mov_b32 v141, 0
    v_mov_b32 v142, 0
    v_mov_b32 v143, 0
    v_mov_b32 v144, 0
    v_mov_b32 v145, 0
    v_mov_b32 v146, 0
    v_mov_b32 v147, 0
    v_mov_b32 v148, 0
    v_mov_b32 v149, 0
    v_mov_b32 v150, 0
    v_mov_b32 v151, 0
    v_mov_b32 v152, 0
    v_mov_b32 v153, 0
    v_mov_b32 v154, 0
    v_mov_b32 v155, 0
    v_mov_b32 v156, 0
    v_mov_b32 v157, 0
    v_mov_b32 v158, 0
    v_mov_b32 v159, 0
    s_waitcnt vmcnt(8) lgkmcnt(0)
    v_perm_b32 v160, v68, v64, s92
    v_perm_b32 v164, v68, v64, s93
    v_perm_b32 v161, v76, v72, s92
    v_perm_b32 v165, v76, v72, s93
    v_perm_b32 v162, v84, v80, s92
    v_perm_b32 v166, v84, v80, s93
    v_perm_b32 v163, v92, v88, s92
    v_perm_b32 v167, v92, v88, s93
    s_nop 0
    v_mfma_f32_16x16x32_bf16 v[128:131], v[48:51], v[160:163], v[128:131]
    v_mfma_f32_16x16x32_bf16 v[132:135], v[48:51], v[164:167], v[132:135]
    v_perm_b32 v8, v69, v65, s92
    v_perm_b32 v12, v69, v65, s93
    v_perm_b32 v9, v77, v73, s92
    v_perm_b32 v13, v77, v73, s93
    v_perm_b32 v10, v85, v81, s92
    v_perm_b32 v14, v85, v81, s93
    v_perm_b32 v11, v93, v89, s92
    v_perm_b32 v15, v93, v89, s93
    s_nop 0
    v_mfma_f32_16x16x32_bf16 v[136:139], v[48:51], v[8:11], v[136:139]
    v_mfma_f32_16x16x32_bf16 v[140:143], v[48:51], v[12:15], v[140:143]
    v_perm_b32 v160, v70, v66, s92
    v_perm_b32 v164, v70, v66, s93
    v_perm_b32 v161, v78, v74, s92
    v_perm_b32 v165, v78, v74, s93
    v_perm_b32 v162, v86, v82, s92
    v_perm_b32 v166, v86, v82, s93
    v_perm_b32 v163, v94, v90, s92
    v_perm_b32 v167, v94, v90, s93
    s_nop 0
    v_mfma_f32_16x16x32_bf16 v[144:147], v[48:51], v[160:163], v[144:147]
    v_mfma_f32_16x16x32_bf16 v[148:151], v[48:51], v[164:167], v[148:151]
    v_perm_b32 v8, v71, v67, s92
    v_perm_b32 v12, v71, v67, s93
    v_perm_b32 v9, v79, v75, s92
    v_perm_b32 v13, v79, v75, s93
    v_perm_b32 v10, v87, v83, s92
    v_perm_b32 v14, v87, v83, s93
    v_perm_b32 v11, v95, v91, s92
    v_perm_b32 v15, v95, v91, s93
    s_nop 0
    v_mfma_f32_16x16x32_bf16 v[152:155], v[48:51], v[8:11], v[152:155]
    v_mfma_f32_16x16x32_bf16 v[156:159], v[48:51], v[12:15], v[156:159]
    s_lshl_b32 s13, s2, 9
    s_add_u32 s13, s13, 262144
    v_cmp_lt_u32 s[8:9], 7, v2
    s_nop 1
    v_cndmask_b32 v24, v128, v130, s[8:9]
    v_cndmask_b32 v32, v129, v131, s[8:9]
    v_cndmask_b32 v25, v132, v134, s[8:9]
    v_cndmask_b32 v33, v133, v135, s[8:9]
    v_cndmask_b32 v26, v136, v138, s[8:9]
    v_cndmask_b32 v34, v137, v139, s[8:9]
    v_cndmask_b32 v27, v140, v142, s[8:9]
    v_cndmask_b32 v35, v141, v143, s[8:9]
    v_cndmask_b32 v28, v144, v146, s[8:9]
    v_cndmask_b32 v36, v145, v147, s[8:9]
    v_cndmask_b32 v29, v148, v150, s[8:9]
    v_cndmask_b32 v37, v149, v151, s[8:9]
    v_cndmask_b32 v30, v152, v154, s[8:9]
    v_cndmask_b32 v38, v153, v155, s[8:9]
    v_cndmask_b32 v31, v156, v158, s[8:9]
    v_cndmask_b32 v39, v157, v159, s[8:9]
    v_add_f32 v24, v24, v24 row_ror:8 row_mask:0xf bank_mask:0xf
    v_add_f32 v25, v25, v25 row_ror:8 row_mask:0xf bank_mask:0xf
    v_add_f32 v26, v26, v26 row_ror:8 row_mask:0xf bank_mask:0xf
    v_add_f32 v27, v27, v27 row_ror:8 row_mask:0xf bank_mask:0xf
    v_add_f32 v28, v28, v28 row_ror:8 row_mask:0xf bank_mask:0xf
    v_add_f32 v29, v29, v29 row_ror:8 row_mask:0xf bank_mask:0xf
    v_add_f32 v30, v30, v30 row_ror:8 row_mask:0xf bank_mask:0xf
    v_add_f32 v31, v31, v31 row_ror:8 row_mask:0xf bank_mask:0xf
    v_add_f32 v32, v32, v32 row_ror:8 row_mask:0xf bank_mask:0xf
    v_add_f32 v33, v33, v33 row_ror:8 row_mask:0xf bank_mask:0xf
    v_add_f32 v34, v34, v34 row_ror:8 row_mask:0xf bank_mask:0xf
    v_add_f32 v35, v35, v35 row_ror:8 row_mask:0xf bank_mask:0xf
    v_add_f32 v36, v36, v36 row_ror:8 row_mask:0xf bank_mask:0xf
    v_add_f32 v37, v37, v37 row_ror:8 row_mask:0xf bank_mask:0xf
    v_add_f32 v38, v38, v38 row_ror:8 row_mask:0xf bank_mask:0xf
    v_add_f32 v39, v39, v39 row_ror:8 row_mask:0xf bank_mask:0xf
    v_and_b32 v6, 1, v3
    v_cmp_eq_u32 s[8:9], 1, v6
    v_cmp_lt_u32 s[10:11], 1, v3
    s_nop 0
    v_cndmask_b32 v16, v24, v28, s[8:9]
    v_cndmask_b32 v20, v32, v36, s[8:9]
    v_cndmask_b32 v17, v25, v29, s[8:9]
    v_cndmask_b32 v21, v33, v37, s[8:9]
    v_cndmask_b32 v18, v26, v30, s[8:9]
    v_cndmask_b32 v22, v34, v38, s[8:9]
    v_cndmask_b32 v19, v27, v31, s[8:9]
    v_cndmask_b32 v23, v35, v39, s[8:9]
    v_cndmask_b32 v16, v16, v20, s[10:11]
    v_cndmask_b32 v17, v17, v21, s[10:11]
    v_cndmask_b32 v18, v18, v22, s[10:11]
    v_cndmask_b32 v19, v19, v23, s[10:11]
    v_lshrrev_b32 v7, 1, v3
    v_lshlrev_b32 v7, 8, v7
    v_lshlrev_b32 v6, 4, v6
    v_add_u32 v7, v7, v6
    v_and_b32 v6, 7, v2
    v_lshlrev_b32 v6, 5, v6
    v_add_u32 v7, v7, v6
    v_cmp_gt_u32 vcc, 8, v2
    s_nop 0
    s_and_saveexec_b64 s[98:99], vcc
    buffer_store_dwordx4 v[16:19], v7, s[52:55], s13 offen sc1
    s_mov_b64 exec, s[98:99]
L_r1_done:
    s_waitcnt vmcnt(0)
    v_mov_b32 v11, 131104
    s_mov_b32 s94, 0
L_r1_wn:
    ds_read_b32 v12, v11
    s_add_u32 s94, s94, 1
    s_waitcnt lgkmcnt(0)
    v_readfirstlane_b32 s9, v12
    s_cmp_gt_u32 s94, 4000000
    s_cbranch_scc1 L_r1_wn_go
    s_cmp_ge_u32 s9, 1
    s_cbranch_scc1 L_r1_wn_go
    s_sleep 1
    s_branch L_r1_wn
L_r1_wn_go:
    ds_read_b64 v[8:9], v11
    v_mov_b32 v10, 0
    s_lshl_b32 s12, s2, 3
    s_add_u32 s12, s12, 524288
    s_waitcnt lgkmcnt(0)
    s_mov_b64 s[98:99], exec
    s_mov_b64 exec, 1
    buffer_store_dwordx2 v[8:9], v10, s[52:55], s12 offen sc1
    s_mov_b64 exec, s[98:99]
    s_branch L_hwait
L_role3:
    s_nop 1
    s_barrier
    s_branch L_hwait
L_role2:
    s_nop 1
    s_mov_b32 s56, s38
    s_and_b32 s57, s39, 0xffff
    s_mov_b32 s58, 256
    s_mov_b32 s59, 0x20000
    s_mov_b32 s80, s30
    s_and_b32 s81, s31, 0xffff
    s_mov_b32 s82, 3584
    s_mov_b32 s83, 0x20000
    v_mov_b32 v4, 0
    s_cmp_ge_u32 s2, 8
    s_cbranch_scc1 L_r2_rd
    s_memrealtime s[10:11]
    s_waitcnt lgkmcnt(0)
    s_or_b32 s10, s10, 1
    v_mov_b32 v8, s10
    v_mov_b32 v9, s11
    v_mov_b32 v10, 0
    v_mov_b32 v11, 0
    s_mov_b64 s[98:99], exec
    s_mov_b64 exec, 1
    buffer_atomic_cmpswap_x2 v[8:11], v4, s[56:59], 0 offen sc0 sc1
    s_mov_b64 exec, s[98:99]
    s_barrier
    s_waitcnt vmcnt(0)
    v_readfirstlane_b32 s12, v8
    v_readfirstlane_b32 s13, v9
    s_cmp_eq_u32 s12, 0
    s_cselect_b32 s12, s10, s12
    s_cselect_b32 s13, s11, s13
    v_mov_b32 v8, s12
    v_mov_b32 v9, s13
    s_branch L_r2_gotn
L_r2_rd:
    s_barrier
    s_sleep 32
    s_mov_b32 s94, 0
L_r2_np:
    buffer_load_dwordx2 v[8:9], v4, s[56:59], 0 offen sc1
    s_add_u32 s94, s94, 1
    s_waitcnt vmcnt(0)
    v_readfirstlane_b32 s10, v8
    s_cmp_gt_u32 s94, 200000
    s_cbranch_scc1 L_r2_gotn
    s_cmp_lg_u32 s10, 0
    s_cbranch_scc1 L_r2_gotn
    s_sleep 12
    s_branch L_r2_np
L_r2_gotn:
    v_mov_b32 v5, 131104
    ds_write_b32 v5, v9 offset:4
    ds_write_b32 v5, v8
    s_lshl_b32 s12, s2, 4
    v_mov_b32 v4, 0
    buffer_load_dwordx4 v[24:27], v4, s[80:83], s12 offen
    s_lshl_b32 s8, s4, 5
    v_and_b32 v4, 31, v0
    v_add_u32 v4, s8, v4
    v_lshlrev_b32 v4, 3, v4
    s_mov_b32 s8, 528384
    v_mov_b32 v11, 131116
    s_mov_b32 s94, 0
L_kw:
    ds_read_b32 v12, v11
    s_add_u32 s94, s94, 1
    s_waitcnt lgkmcnt(0)
    v_readfirstlane_b32 s9, v12
    s_cmp_gt_u32 s94, 4000000
    s_cbranch_scc1 L_kw_go
    s_cmp_ge_u32 s9, 1
    s_cbranch_scc1 L_kw_go
    s_sleep 4
    s_branch L_kw
L_kw_go:
    s_mov_b32 s94, 0
L_r2_poll:
    buffer_load_dwordx2 v[16:17], v4, s[52:55], s8 offen sc1
    s_add_u32 s94, s94, 1
    s_waitcnt vmcnt(0)
    v_xor_b32 v16, v16, v8
    v_xor_b32 v17, v17, v9
    v_or_b32 v16, v16, v17
    v_cmp_ne_u32 vcc, 0, v16
    s_cmp_gt_u32 s94, 200000
    s_cbranch_scc1 L_r2_go
    s_cbranch_vccz L_r2_go
    s_sleep 16
    s_branch L_r2_poll
L_r2_go:
    v_lshlrev_b32 v4, 1, v3
    v_lshrrev_b32 v5, 3, v2
    v_add_u32 v4, v4, v5
    v_lshlrev_b32 v4, 11, v4
    v_and_b32 v5, 7, v2
    v_lshlrev_b32 v5, 5, v5
    v_add_u32 v4, v4, v5
    s_lshl_b32 s8, s4, 14
    s_lshl_b32 s9, s6, 8
    s_add_u32 s8, s8, s9
    buffer_load_dwordx4 v[64:67], v4, s[52:55], s8 offen offset:0 sc1
    buffer_load_dwordx4 v[68:71], v4, s[52:55], s8 offen offset:16 sc1
    buffer_load_dwordx4 v[72:75], v4, s[52:55], s8 offen offset:512 sc1
    buffer_load_dwordx4 v[76:79], v4, s[52:55], s8 offen offset:528 sc1
    buffer_load_dwordx4 v[80:83], v4, s[52:55], s8 offen offset:1024 sc1
    buffer_load_dwordx4 v[84:87], v4, s[52:55], s8 offen offset:1040 sc1
    buffer_load_dwordx4 v[88:91], v4, s[52:55], s8 offen offset:1536 sc1
    buffer_load_dwordx4 v[92:95], v4, s[52:55], s8 offen offset:1552 sc1
    v_lshlrev_b32 v29, 5, v0
    s_mov_b32 s14, 524288
    buffer_load_dwordx4 v[32:35], v29, s[52:55], s14 offen sc1
    buffer_load_dwordx4 v[36:39], v29, s[52:55], s14 offen offset:16 sc1
    s_waitcnt vmcnt(6)
    v_add_f32 v64, v64, v72
    v_add_f32 v65, v65, v73
    v_add_f32 v66, v66, v74
    v_add_f32 v67, v67, v75
    v_add_f32 v68, v68, v76
    v_add_f32 v69, v69, v77
    v_add_f32 v70, v70, v78
    v_add_f32 v71, v71, v79
    s_waitcnt vmcnt(4)
    v_add_f32 v64, v64, v80
    v_add_f32 v65, v65, v81
    v_add_f32 v66, v66, v82
    v_add_f32 v67, v67, v83
    v_add_f32 v68, v68, v84
    v_add_f32 v69, v69, v85
    v_add_f32 v70, v70, v86
    v_add_f32 v71, v71, v87
    s_waitcnt vmcnt(2)
    v_add_f32 v64, v64, v88
    v_add_f32 v65, v65, v89
    v_add_f32 v66, v66, v90
    v_add_f32 v67, v67, v91
    v_add_f32 v68, v68, v92
    v_add_f32 v69, v69, v93
    v_add_f32 v70, v70, v94
    v_add_f32 v71, v71, v95
    v_cvt_pk_bf16_f32 v16, v64, v65
    v_cvt_pk_bf16_f32 v17, v66, v67
    v_cvt_pk_bf16_f32 v18, v68, v69
    v_cvt_pk_bf16_f32 v19, v70, v71
    v_mul_u32_u24 v4, 272, v3
    v_lshlrev_b32 v5, 4, v2
    v_add_u32 v4, v4, v5
    v_add_u32 v4, 131136, v4
    ds_write_b128 v4, v[16:19]
    v_mov_b32 v5, 131088
    v_mov_b32 v6, 1
    ds_write_b32 v5, v6
    s_mov_b32 s94, 0
    s_waitcnt vmcnt(0)
L_fl_chk:
    v_xor_b32 v32, v32, v8
    v_xor_b32 v33, v33, v9
    v_xor_b32 v34, v34, v8
    v_xor_b32 v35, v35, v9
    v_xor_b32 v36, v36, v8
    v_xor_b32 v37, v37, v9
    v_xor_b32 v38, v38, v8
    v_xor_b32 v39, v39, v9
    v_or3_b32 v32, v32, v33, v34
    v_or3_b32 v32, v32, v35, v36
    v_or3_b32 v32, v32, v37, v38
    v_or_b32 v32, v32, v39
    v_cmp_ne_u32 vcc, 0, v32
    s_add_u32 s94, s94, 1
    s_cmp_gt_u32 s94, 200000
    s_cbranch_scc1 L_fl_go
    s_cbranch_vccz L_fl_go
    s_sleep 16
    buffer_load_dwordx4 v[32:35], v29, s[52:55], s14 offen sc1
    buffer_load_dwordx4 v[36:39], v29, s[52:55], s14 offen offset:16 sc1
    s_waitcnt vmcnt(0)
    s_branch L_fl_chk
L_fl_go:
    v_and_b32 v5, 7, v0
    v_lshlrev_b32 v5, 9, v5
    v_bfe_u32 v6, v0, 3, 1
    v_lshlrev_b32 v6, 4, v6
    v_add_u32 v5, v5, v6
    v_bfe_u32 v6, v0, 4, 1
    v_lshlrev_b32 v6, 8, v6
    v_add_u32 v5, v5, v6
    s_lshr_b32 s9, s2, 3
    s_lshl_b32 s9, s9, 12
    s_and_b32 s10, s2, 7
    s_lshl_b32 s10, s10, 5
    s_add_u32 s9, s9, s10
    s_add_u32 s9, s9, 262144
    buffer_load_dwordx4 v[96:99], v5, s[52:55], s9 offen sc1
    s_waitcnt vmcnt(0)
    v_add_f32 v96, v96, v96 quad_perm:[1,0,3,2] row_mask:0xf bank_mask:0xf
    v_add_f32 v97, v97, v97 quad_perm:[1,0,3,2] row_mask:0xf bank_mask:0xf
    v_add_f32 v98, v98, v98 quad_perm:[1,0,3,2] row_mask:0xf bank_mask:0xf
    v_add_f32 v99, v99, v99 quad_perm:[1,0,3,2] row_mask:0xf bank_mask:0xf
    v_add_f32 v96, v96, v96 quad_perm:[2,3,0,1] row_mask:0xf bank_mask:0xf
    v_add_f32 v97, v97, v97 quad_perm:[2,3,0,1] row_mask:0xf bank_mask:0xf
    v_add_f32 v98, v98, v98 quad_perm:[2,3,0,1] row_mask:0xf bank_mask:0xf
    v_add_f32 v99, v99, v99 quad_perm:[2,3,0,1] row_mask:0xf bank_mask:0xf
    v_add_f32 v96, v96, v96 row_half_mirror row_mask:0xf bank_mask:0xf
    v_add_f32 v97, v97, v97 row_half_mirror row_mask:0xf bank_mask:0xf
    v_add_f32 v98, v98, v98 row_half_mirror row_mask:0xf bank_mask:0xf
    v_add_f32 v99, v99, v99 row_half_mirror row_mask:0xf bank_mask:0xf
    v_bfe_u32 v6, v0, 3, 1
    v_cmp_eq_u32 vcc, 1, v6
    s_nop 1
    v_cndmask_b32 v24, v24, v26, vcc
    v_cndmask_b32 v25, v25, v27, vcc
    v_cvt_pk_bf16_f32 v28, v96, v97
    v_cvt_pk_bf16_f32 v30, v98, v99
    v_lshlrev_b32 v96, 16, v28
    v_and_b32 v97, 0xffff0000, v28
    v_lshlrev_b32 v98, 16, v30
    v_and_b32 v99, 0xffff0000, v30
    v_lshlrev_b32 v100, 16, v24
    v_and_b32 v101, 0xffff0000, v24
    v_lshlrev_b32 v102, 16, v25
    v_and_b32 v103, 0xffff0000, v25
    v_add_f32 v96, v96, v100
    v_add_f32 v97, v97, v101
    v_add_f32 v98, v98, v102
    v_add_f32 v99, v99, v103
    v_cvt_pk_bf16_f32 v28, v96, v97
    v_cvt_pk_bf16_f32 v30, v98, v99
    v_lshlrev_b32 v96, 16, v28
    v_and_b32 v97, 0xffff0000, v28
    v_lshlrev_b32 v98, 16, v30
    v_and_b32 v99, 0xffff0000, v30
    s_mov_b32 s8, 0x3d372713
    s_mov_b32 s9, 0xc0135761
    v_mul_f32 v100, v96, v96
    v_mul_f32 v100, v100, v96
    v_fma_f32 v100, v100, s8, v96
    v_mul_f32 v100, s9, v100
    v_mul_f32 v101, v97, v97
    v_mul_f32 v101, v101, v97
    v_fma_f32 v101, v101, s8, v97
    v_mul_f32 v101, s9, v101
    v_mul_f32 v102, v98, v98
    v_mul_f32 v102, v102, v98
    v_fma_f32 v102, v102, s8, v98
    v_mul_f32 v102, s9, v102
    v_mul_f32 v103, v99, v99
    v_mul_f32 v103, v103, v99
    v_fma_f32 v103, v103, s8, v99
    v_mul_f32 v103, s9, v103
    v_exp_f32 v100, v100
    v_exp_f32 v101, v101
    v_exp_f32 v102, v102
    v_exp_f32 v103, v103
    v_add_f32 v100, 1.0, v100
    v_add_f32 v101, 1.0, v101
    v_add_f32 v102, 1.0, v102
    v_add_f32 v103, 1.0, v103
    v_rcp_f32 v100, v100
    v_rcp_f32 v101, v101
    v_rcp_f32 v102, v102
    v_rcp_f32 v103, v103
    v_mul_f32 v96, v96, v100
    v_mul_f32 v97, v97, v101
    v_mul_f32 v98, v98, v102
    v_mul_f32 v99, v99, v103
    v_cvt_pk_bf16_f32 v26, v96, v97
    v_cvt_pk_bf16_f32 v27, v98, v99
    s_cmp_lt_u32 s2, 224
    s_cbranch_scc1 L_r2_hok
    v_mov_b32 v26, 0
    v_mov_b32 v27, 0
L_r2_hok:
    v_bfe_u32 v5, v0, 4, 1
    v_lshlrev_b32 v5, 4, v5
    v_lshlrev_b32 v6, 3, v6
    v_add_u32 v5, v5, v6
    v_add_u32 v5, 137216, v5
    s_mov_b32 exec_hi, 0
    ds_write_b64 v5, v[26:27]
    s_mov_b32 exec_hi, -1
L_hwait:
    s_nop 1
    s_mov_b32 s68, s24
    s_and_b32 s69, s25, 0xffff
    s_mov_b32 s70, 4194304
    s_mov_b32 s71, 0x20000
    s_mov_b32 s76, s32
    s_and_b32 s77, s33, 0xffff
    s_mov_b32 s78, 1835008
    s_mov_b32 s79, 0x20000
    v_and_b32 v13, 1, v3
    v_lshlrev_b32 v15, 13, v13
    v_lshlrev_b32 v14, 4, v2
    v_add_u32 v15, v15, v14
    v_lshlrev_b32 v13, 12, v13
    v_add_u32 v13, v13, v14
    s_lshl_b32 s13, s2, 14
    s_lshl_b32 s10, s3, 8
    s_add_u32 s13, s13, s10
    s_add_u32 s11, s13, 4096
    s_lshl_b32 s12, s2, 13
    s_add_u32 s12, s12, s10
    s_mov_b32 s17, s13
    s_mov_b32 s18, s11
    s_mov_b32 s19, s12
    v_mov_b32 v11, 131092
    s_mov_b32 s94, 0
L_tw:
    ds_read_b32 v12, v11
    s_add_u32 s94, s94, 1
    s_waitcnt lgkmcnt(0)
    v_readfirstlane_b32 s9, v12
    s_cmp_gt_u32 s94, 4000000
    s_cbranch_scc1 L_tw_go
    s_cmp_ge_u32 s9, 8
    s_cbranch_scc1 L_tw_go
    s_sleep 2
    s_branch L_tw
L_tw_go:
    buffer_load_dwordx4 v[64:67], v15, s[68:71], s17 offen offset:0 nt
    buffer_load_dwordx4 v[68:71], v15, s[68:71], s17 offen offset:1024 nt
    buffer_load_dwordx4 v[72:75], v15, s[68:71], s17 offen offset:2048 nt
    buffer_load_dwordx4 v[76:79], v15, s[68:71], s17 offen offset:3072 nt
    buffer_load_dwordx4 v[80:83], v15, s[68:71], s18 offen offset:0 nt
    buffer_load_dwordx4 v[84:87], v15, s[68:71], s18 offen offset:1024 nt
    buffer_load_dwordx4 v[88:91], v15, s[68:71], s18 offen offset:2048 nt
    buffer_load_dwordx4 v[92:95], v15, s[68:71], s18 offen offset:3072 nt
    buffer_load_dwordx4 v[96:99], v13, s[76:79], s19 offen offset:0 nt
    buffer_load_dwordx4 v[100:103], v13, s[76:79], s19 offen offset:1024 nt
    buffer_load_dwordx4 v[104:107], v13, s[76:79], s19 offen offset:2048 nt
    buffer_load_dwordx4 v[108:111], v13, s[76:79], s19 offen offset:3072 nt
    v_lshlrev_b32 v30, 3, v3
    v_add_u32 v30, 137216, v30
    v_and_b32 v7, 1, v2
    v_lshrrev_b32 v6, 1, v3
    v_cmp_eq_u32 s[14:15], v6, v7
    v_lshrrev_b32 v26, 1, v2
    s_lshl_b32 s10, s3, 3
    v_add_u32 v26, s10, v26
    v_lshrrev_b32 v27, 1, v3
    v_lshlrev_b32 v27, 5, v27
    v_add_u32 v26, v26, v27
    v_lshlrev_b32 v26, 14, v26
    v_and_b32 v27, 1, v2
    v_lshlrev_b32 v27, 5, v27
    v_add_u32 v26, v26, v27
    v_and_b32 v27, 1, v3
    v_cmp_eq_u32 s[10:11], 1, v27
    v_lshlrev_b32 v27, 4, v27
    v_add_u32 v26, v26, v27
    v_cmp_lt_u32 s[12:13], 1, v3
    s_lshl_b32 s99, s2, 6
    s_add_u32 s99, s99, 2097152
    v_lshrrev_b32 v6, 1, v3
    v_lshlrev_b32 v6, 4, v6
    v_add_u32 v6, v6, v2
    v_lshlrev_b32 v5, 7, v6
    v_and_b32 v4, 1, v3
    v_lshlrev_b32 v4, 5, v4
    v_add_u32 v4, v4, v5
    s_lshl_b32 s8, s2, 12
    s_add_u32 s8, s8, 1048576
    v_lshlrev_b32 v27, 4, v3
    v_add_u32 v27, 137280, v27
    v_mov_b32 v28, 131100
    s_barrier
    ds_read_b64 v[8:9], v30
    s_waitcnt lgkmcnt(0)
    v_cndmask_b32 v8, 0, v8, s[14:15]
    v_cndmask_b32 v9, 0, v9, s[14:15]
    s_waitcnt vmcnt(0)
    v_perm_b32 v144, v100, v96, s92
    v_perm_b32 v146, v100, v96, s93
    v_perm_b32 v145, v108, v104, s92
    v_perm_b32 v147, v108, v104, s93
    v_perm_b32 v148, v101, v97, s92
    v_perm_b32 v150, v101, v97, s93
    v_perm_b32 v149, v109, v105, s92
    v_perm_b32 v151, v109, v105, s93
    v_perm_b32 v152, v102, v98, s92
    v_perm_b32 v154, v102, v98, s93
    v_perm_b32 v153, v110, v106, s92
    v_perm_b32 v155, v110, v106, s93
    v_perm_b32 v156, v103, v99, s92
    v_perm_b32 v158, v103, v99, s93
    v_perm_b32 v157, v111, v107, s92
    v_perm_b32 v159, v111, v107, s93
    v_perm_b32 v112, v68, v64, s92
    v_perm_b32 v116, v68, v64, s93
    v_perm_b32 v113, v76, v72, s92
    v_perm_b32 v117, v76, v72, s93
    v_perm_b32 v114, v84, v80, s92
    v_perm_b32 v118, v84, v80, s93
    v_perm_b32 v115, v92, v88, s92
    v_perm_b32 v119, v92, v88, s93
    v_perm_b32 v120, v69, v65, s92
    v_perm_b32 v124, v69, v65, s93
    v_perm_b32 v121, v77, v73, s92
    v_perm_b32 v125, v77, v73, s93
    v_perm_b32 v122, v85, v81, s92
    v_perm_b32 v126, v85, v81, s93
    v_perm_b32 v123, v93, v89, s92
    v_perm_b32 v127, v93, v89, s93
    v_perm_b32 v128, v70, v66, s92
    v_perm_b32 v132, v70, v66, s93
    v_perm_b32 v129, v78, v74, s92
    v_perm_b32 v133, v78, v74, s93
    v_perm_b32 v130, v86, v82, s92
    v_perm_b32 v134, v86, v82, s93
    v_perm_b32 v131, v94, v90, s92
    v_perm_b32 v135, v94, v90, s93
    v_perm_b32 v136, v71, v67, s92
    v_perm_b32 v140, v71, v67, s93
    v_perm_b32 v137, v79, v75, s92
    v_perm_b32 v141, v79, v75, s93
    v_perm_b32 v138, v87, v83, s92
    v_perm_b32 v142, v87, v83, s93
    v_perm_b32 v139, v95, v91, s92
    v_perm_b32 v143, v95, v91, s93
    v_mov_b32 v64, 0
    v_mov_b32 v65, 0
    v_mov_b32 v66, 0
    v_mov_b32 v67, 0
    v_mov_b32 v68, 0
    v_mov_b32 v69, 0
    v_mov_b32 v70, 0
    v_mov_b32 v71, 0
    v_mov_b32 v72, 0
    v_mov_b32 v73, 0
    v_mov_b32 v74, 0
    v_mov_b32 v75, 0
    v_mov_b32 v76, 0
    v_mov_b32 v77, 0
    v_mov_b32 v78, 0
    v_mov_b32 v79, 0
    v_mov_b32 v80, 0
    v_mov_b32 v81, 0
    v_mov_b32 v82, 0
    v_mov_b32 v83, 0
    v_mov_b32 v84, 0
    v_mov_b32 v85, 0
    v_mov_b32 v86, 0
    v_mov_b32 v87, 0
    v_mov_b32 v88, 0
    v_mov_b32 v89, 0
    v_mov_b32 v90, 0
    v_mov_b32 v91, 0
    v_mov_b32 v92, 0
    v_mov_b32 v93, 0
    v_mov_b32 v94, 0
    v_mov_b32 v95, 0
    v_mfma_f32_16x16x16_bf16 v[64:67], v[8:9], v[144:145], v[64:67]
    v_mfma_f32_16x16x16_bf16 v[68:71], v[8:9], v[146:147], v[68:71]
    v_mfma_f32_16x16x16_bf16 v[72:75], v[8:9], v[148:149], v[72:75]
    v_mfma_f32_16x16x16_bf16 v[76:79], v[8:9], v[150:151], v[76:79]
    v_mfma_f32_16x16x16_bf16 v[80:83], v[8:9], v[152:153], v[80:83]
    v_mfma_f32_16x16x16_bf16 v[84:87], v[8:9], v[154:155], v[84:87]
    v_mfma_f32_16x16x16_bf16 v[88:91], v[8:9], v[156:157], v[88:91]
    v_mfma_f32_16x16x16_bf16 v[92:95], v[8:9], v[158:159], v[92:95]
    s_cmp_lg_u32 s3, 0
    s_cbranch_scc1 L_g_wait
    s_sleep 8
    s_mov_b32 s94, 0
    s_mov_b32 s9, 0x3fb8aa3b
    s_mov_b64 s[96:97], -1
L_g_poll:
    s_mov_b64 exec, s[96:97]
    buffer_load_dwordx2 v[24:25], v5, s[52:55], s8 offen offset:64 sc1
    buffer_load_dwordx4 v[16:19], v4, s[52:55], s8 offen sc1
    buffer_load_dwordx4 v[20:23], v4, s[52:55], s8 offen offset:16 sc1
    s_mov_b64 exec, -1
    s_add_u32 s94, s94, 1
    s_waitcnt vmcnt(0)
    v_max3_u32 v6, v16, v17, v18
    v_max3_u32 v6, v6, v19, v20
    v_max3_u32 v6, v6, v21, v22
    v_max3_u32 v6, v6, v23, v24
    v_max_u32 v6, v6, v25
    v_cmp_eq_u32 s[96:97], -1, v6
    s_cmp_gt_u32 s94, 200000
    s_cbranch_scc1 L_g_go
    s_cmp_eq_u64 s[96:97], 0
    s_cbranch_scc1 L_g_go
    s_branch L_g_poll
L_g_go:
    v_mov_b32 v6, v25
    s_nop 1
    v_max_f32 v6, v6, v6 row_ror:8 row_mask:0xf bank_mask:0xf
    s_nop 1
    v_max_f32 v6, v6, v6 row_ror:4 row_mask:0xf bank_mask:0xf
    s_nop 1
    v_max_f32 v6, v6, v6 row_ror:2 row_mask:0xf bank_mask:0xf
    s_nop 1
    v_max_f32 v6, v6, v6 row_ror:1 row_mask:0xf bank_mask:0xf
    v_sub_f32 v6, v25, v6
    v_mul_f32 v6, s9, v6
    v_exp_f32 v6, v6
    s_nop 0
    v_mul_f32 v24, v24, v6
    v_mul_f32 v16, v16, v6
    v_mul_f32 v17, v17, v6
    v_mul_f32 v18, v18, v6
    v_mul_f32 v19, v19, v6
    v_mul_f32 v20, v20, v6
    v_mul_f32 v21, v21, v6
    v_mul_f32 v22, v22, v6
    v_mul_f32 v23, v23, v6
    v_add_f32 v24, v24, v24 row_ror:8 row_mask:0xf bank_mask:0xf
    v_add_f32 v16, v16, v16 row_ror:8 row_mask:0xf bank_mask:0xf
    v_add_f32 v17, v17, v17 row_ror:8 row_mask:0xf bank_mask:0xf
    v_add_f32 v18, v18, v18 row_ror:8 row_mask:0xf bank_mask:0xf
    v_add_f32 v19, v19, v19 row_ror:8 row_mask:0xf bank_mask:0xf
    v_add_f32 v20, v20, v20 row_ror:8 row_mask:0xf bank_mask:0xf
    v_add_f32 v21, v21, v21 row_ror:8 row_mask:0xf bank_mask:0xf
    v_add_f32 v22, v22, v22 row_ror:8 row_mask:0xf bank_mask:0xf
    v_add_f32 v23, v23, v23 row_ror:8 row_mask:0xf bank_mask:0xf
    v_add_f32 v24, v24, v24 row_ror:4 row_mask:0xf bank_mask:0xf
    v_add_f32 v16, v16, v16 row_ror:4 row_mask:0xf bank_mask:0xf
    v_add_f32 v17, v17, v17 row_ror:4 row_mask:0xf bank_mask:0xf
    v_add_f32 v18, v18, v18 row_ror:4 row_mask:0xf bank_mask:0xf
    v_add_f32 v19, v19, v19 row_ror:4 row_mask:0xf bank_mask:0xf
    v_add_f32 v20, v20, v20 row_ror:4 row_mask:0xf bank_mask:0xf
    v_add_f32 v21, v21, v21 row_ror:4 row_mask:0xf bank_mask:0xf
    v_add_f32 v22, v22, v22 row_ror:4 row_mask:0xf bank_mask:0xf
    v_add_f32 v23, v23, v23 row_ror:4 row_mask:0xf bank_mask:0xf
    v_add_f32 v24, v24, v24 row_ror:2 row_mask:0xf bank_mask:0xf
    v_add_f32 v16, v16, v16 row_ror:2 row_mask:0xf bank_mask:0xf
    v_add_f32 v17, v17, v17 row_ror:2 row_mask:0xf bank_mask:0xf
    v_add_f32 v18, v18, v18 row_ror:2 row_mask:0xf bank_mask:0xf
    v_add_f32 v19, v19, v19 row_ror:2 row_mask:0xf bank_mask:0xf
    v_add_f32 v20, v20, v20 row_ror:2 row_mask:0xf bank_mask:0xf
    v_add_f32 v21, v21, v21 row_ror:2 row_mask:0xf bank_mask:0xf
    v_add_f32 v22, v22, v22 row_ror:2 row_mask:0xf bank_mask:0xf
    v_add_f32 v23, v23, v23 row_ror:2 row_mask:0xf bank_mask:0xf
    v_add_f32 v24, v24, v24 row_ror:1 row_mask:0xf bank_mask:0xf
    v_add_f32 v16, v16, v16 row_ror:1 row_mask:0xf bank_mask:0xf
    v_add_f32 v17, v17, v17 row_ror:1 row_mask:0xf bank_mask:0xf
    v_add_f32 v18, v18, v18 row_ror:1 row_mask:0xf bank_mask:0xf
    v_add_f32 v19, v19, v19 row_ror:1 row_mask:0xf bank_mask:0xf
    v_add_f32 v20, v20, v20 row_ror:1 row_mask:0xf bank_mask:0xf
    v_add_f32 v21, v21, v21 row_ror:1 row_mask:0xf bank_mask:0xf
    v_add_f32 v22, v22, v22 row_ror:1 row_mask:0xf bank_mask:0xf
    v_add_f32 v23, v23, v23 row_ror:1 row_mask:0xf bank_mask:0xf
    v_rcp_f32 v24, v24
    s_nop 0
    v_mul_f32 v16, v16, v24
    v_mul_f32 v17, v17, v24
    v_mul_f32 v18, v18, v24
    v_mul_f32 v19, v19, v24
    v_mul_f32 v20, v20, v24
    v_mul_f32 v21, v21, v24
    v_mul_f32 v22, v22, v24
    v_mul_f32 v23, v23, v24
    v_cvt_pk_bf16_f32 v8, v16, v17
    v_cvt_pk_bf16_f32 v9, v18, v19
    v_cvt_pk_bf16_f32 v10, v20, v21
    v_cvt_pk_bf16_f32 v11, v22, v23
    v_cmp_eq_u32 vcc, 0, v2
    s_nop 0
    s_and_saveexec_b64 s[96:97], vcc
    ds_write_b128 v27, v[8:11]
    s_mov_b64 exec, s[96:97]
    v_mov_b32 v6, 1
    ds_write_b32 v28, v6
    s_branch L_g_mm
L_g_wait:
    s_nop 1
    s_mov_b32 s94, 0
L_gw:
    ds_read_b32 v12, v28
    s_add_u32 s94, s94, 1
    s_waitcnt lgkmcnt(0)
    v_readfirstlane_b32 s9, v12
    s_cmp_gt_u32 s94, 4000000
    s_cbranch_scc1 L_gw_go
    s_cmp_ge_u32 s9, 1
    s_cbranch_scc1 L_gw_go
    s_branch L_gw
L_gw_go:
    ds_read_b128 v[8:11], v27
    s_waitcnt lgkmcnt(0)
L_g_mm:
    v_cndmask_b32 v8, 0, v8, s[14:15]
    v_cndmask_b32 v9, 0, v9, s[14:15]
    v_cndmask_b32 v10, 0, v10, s[14:15]
    v_cndmask_b32 v11, 0, v11, s[14:15]
    s_nop 1
    v_mfma_f32_16x16x32_bf16 v[64:67], v[8:11], v[112:115], v[64:67]
    v_mfma_f32_16x16x32_bf16 v[68:71], v[8:11], v[116:119], v[68:71]
    v_mfma_f32_16x16x32_bf16 v[72:75], v[8:11], v[120:123], v[72:75]
    v_mfma_f32_16x16x32_bf16 v[76:79], v[8:11], v[124:127], v[76:79]
    v_mfma_f32_16x16x32_bf16 v[80:83], v[8:11], v[128:131], v[80:83]
    v_mfma_f32_16x16x32_bf16 v[84:87], v[8:11], v[132:135], v[84:87]
    v_mfma_f32_16x16x32_bf16 v[88:91], v[8:11], v[136:139], v[88:91]
    v_mfma_f32_16x16x32_bf16 v[92:95], v[8:11], v[140:143], v[92:95]
    s_nop 4
    v_cndmask_b32 v16, v64, v80, s[10:11]
    v_cndmask_b32 v20, v65, v81, s[10:11]
    v_cndmask_b32 v17, v68, v84, s[10:11]
    v_cndmask_b32 v21, v69, v85, s[10:11]
    v_cndmask_b32 v18, v72, v88, s[10:11]
    v_cndmask_b32 v22, v73, v89, s[10:11]
    v_cndmask_b32 v19, v76, v92, s[10:11]
    v_cndmask_b32 v23, v77, v93, s[10:11]
    v_cndmask_b32 v16, v16, v20, s[12:13]
    v_cndmask_b32 v17, v17, v21, s[12:13]
    v_cndmask_b32 v18, v18, v22, s[12:13]
    v_cndmask_b32 v19, v19, v23, s[12:13]
    v_min_u32 v16, -2, v16
    v_min_u32 v17, -2, v17
    v_min_u32 v18, -2, v18
    v_min_u32 v19, -2, v19
    buffer_store_dwordx4 v[16:19], v26, s[52:55], s99 offen sc1
L_end:
L_exit:
    s_endpgm
.section .rodata,"a"
.p2align 6
.amdhsa_kernel parallel_sum__gqa_block_cached__dense_activation_gelu__decode_kernel
  .amdhsa_next_free_vgpr 168
  .amdhsa_next_free_sgpr 102
  .amdhsa_accum_offset 168
  .amdhsa_group_segment_fixed_size 0
  .amdhsa_kernarg_size 104
  .amdhsa_user_sgpr_count 2
  .amdhsa_user_sgpr_kernarg_segment_ptr 1
  .amdhsa_system_sgpr_workgroup_id_x 1
.end_amdhsa_kernel
```
